```python
import torch

def _softmax(x, axis=-1):
    return torch.softmax(x, dim=axis)
def _gelu(x):
    return torch.nn.functional.gelu(x, approximate="tanh")
def _silu(x):
    return torch.nn.functional.silu(x)
def _sigmoid(x):
    return torch.sigmoid(x)
def _layernorm(x, axis=-1, eps=1e-5):
    m = x.mean(dim=axis, keepdim=True)
    v = x.var(dim=axis, keepdim=True, unbiased=False)
    return (x - m) / torch.sqrt(v + eps)
def _scatter_add(tgt, idx, src, axis=0):
    return tgt.clone().index_add_(axis, idx, src)
def _segment_sum(src, seg, n):
    out = torch.zeros((n,) + src.shape[1:], dtype=src.dtype)
    return out.index_add_(0, seg, src)
def _pad(x, pw):
    flat = tuple(v for pair in reversed(pw) for v in pair)
    return torch.nn.functional.pad(x, flat)

kernel_name = 'gated_mix__linear_attn_block__glu_gated_bilinear__prompt'

def setup_inputs():

    _w = (lambda a: (lambda t: t.to(torch.bfloat16) if t.is_floating_point() else t)(torch.as_tensor(a)))
    def _A_setup():
        B, S, D = 1, 2048, 1024
        return {
            "x": _w((lambda *s: torch.randn(*s, dtype=torch.bfloat16) * 0.05)(B, S, D)),
            "wqkv": _w((lambda *s: torch.randn(*s, dtype=torch.bfloat16) * 0.8)(D, 3 * D)),
            "wo": _w((lambda *s: torch.randn(*s, dtype=torch.bfloat16) * 0.05)(D, D)),
        }
    _A_in = _A_setup()

    def _B_setup():
        B, S, D, F = 1, 2048, 1024, 3584
        return {
            "x": _w((lambda *s: torch.randn(*s, dtype=torch.bfloat16) * 0.05)(B, S, D)),
            "w_gate": _w((lambda *s: torch.randn(*s, dtype=torch.bfloat16) * 1.6)(D, F) * (D ** -0.5)),
            "w_up": _w((lambda *s: torch.randn(*s, dtype=torch.bfloat16) * 1.6)(D, F) * (D ** -0.5)),
            "w_down": _w((lambda *s: torch.randn(*s, dtype=torch.bfloat16) * 1.6)(F, D) * (F ** -0.5)),
        }
    _B_in = _B_setup()

    return {
        "A_x": _A_in["x"],
        "A_wqkv": _A_in["wqkv"],
        "A_wo": _A_in["wo"],
        "B_x": _B_in["x"],
        "B_w_gate": _B_in["w_gate"],
        "B_w_up": _B_in["w_up"],
        "B_w_down": _B_in["w_down"],
        "gate_w": _w((lambda *s: torch.randn(*s, dtype=torch.bfloat16) * 0.05)(1024) * 16.0),
    }

def reference(A_x, A_wqkv, A_wo, B_x, B_w_gate, B_w_up, B_w_down, gate_w):
    def _A_ref(x, wqkv, wo):
        B, S, D = x.shape
        H = 32; Dh = D // H
        qkv = (lambda x, *d: x.permute(*d))((x @ wqkv).reshape(B, S, 3, H, Dh), 2, 0, 3, 1, 4)
        q, k, v = qkv[0], qkv[1], qkv[2]
        phi = lambda t: torch.where(t > 0, t + 1, torch.exp(t)) + 1e-6
        pq, pk = phi(q), phi(k)
        kv = torch.einsum("bhsd,bhse->bhde", pk, v)
        z = torch.einsum("bhsd->bhd", pk)
        num = torch.einsum("bhqd,bhde->bhqe", pq, kv)
        den = torch.einsum("bhqd,bhd->bhq", pq, z)[..., None] + 1e-6
        o = num / den
        return (lambda x, *d: x.permute(*d))(o, 0, 2, 1, 3).reshape(B, S, D) @ wo

    def _B_ref(x, w_gate, w_up, w_down):
        g = torch.einsum("bsd,df->bsf", x, w_gate)
        u = torch.einsum("bsd,df->bsf", x, w_up)
        h = g * u
        return torch.einsum("bsf,fd->bsd", h, w_down)

    x = A_x
    g = _sigmoid((x * gate_w).sum(-1, keepdims=True))
    a = _A_ref(x, A_wqkv, A_wo)
    b = _B_ref(x, B_w_gate, B_w_up, B_w_down)
    return g * a + (1 - g) * b
```

```asm
; @launch kernel=k1_kernel grid=(256,1,1) block=(512,1,1) lds=147456
; @launch kernel=k2_kernel grid=(256,1,1) block=(256,1,1) lds=131072
.amdgcn_target "amdgcn-amd-amdhsa--gfx950"
.text
    .globl k1_kernel
    .p2align 8
    .type k1_kernel,@function
k1_kernel:
    s_cmp_ge_u32 s2, 256
    s_cbranch_scc1 k1_kernel_done
    s_load_dwordx2 s[28:29], s[0:1], 0
    s_load_dwordx2 s[16:17], s[0:1], 8
    s_load_dwordx2 s[24:25], s[0:1], 16
    s_load_dwordx4 s[12:15], s[0:1], 32
    s_load_dwordx2 s[26:27], s[0:1], 48
    s_load_dwordx2 s[18:19], s[0:1], 56
    s_load_dwordx4 s[20:23], s[0:1], 72
    v_and_b32 v1, 63, v0
    v_lshrrev_b32 v2, 6, v0
    s_nop 0
    v_readfirstlane_b32 s32, v2
    s_and_b32 s31, s2, 7
    s_lshl_b32 s31, s31, 2
    s_lshr_b32 s82, s2, 6
    s_add_u32 s31, s31, s82
    s_lshr_b32 s30, s2, 3
    s_and_b32 s30, s30, 7
    s_and_b32 s33, s32, 3
    s_lshr_b32 s34, s32, 2
    s_mul_i32 s35, s31, 224
    s_lshl_b32 s36, s31, 6
    v_lshrrev_b32 v2, 4, v1
    v_and_b32 v3, 3, v1
    v_lshrrev_b32 v4, 2, v1
    v_and_b32 v4, 3, v4
    v_and_b32 v5, 15, v1
    v_lshrrev_b32 v21, 1, v2
    v_and_b32 v22, 1, v2
    v_xor_b32 v22, v22, v21
    v_lshlrev_b32 v22, 1, v22
    v_or_b32 v22, v22, v21
    v_xor_b32 v22, v22, v3
    v_lshlrev_b32 v22, 4, v22
    v_lshrrev_b32 v21, 2, v1
    v_lshlrev_b32 v21, 11, v21
    v_add_u32 v25, v21, v22
    s_waitcnt lgkmcnt(0)
    s_mov_b32 s4, s28
    s_mov_b32 s5, s29
    s_mov_b32 s6, 4194304
    s_mov_b32 s7, 0x00020000
    s_mov_b32 s8, s22
    s_mov_b32 s9, s23
    s_mov_b32 s10, 28844288
    s_mov_b32 s11, 0x00020000
    s_mov_b32 s37, 0
    s_mov_b32 s38, 0
    s_mul_i32 s84, s32, 3
    s_lshl_b32 s85, s32, 1
    s_add_u32 s85, s85, 4
    s_cmp_lt_u32 s32, 4
    s_cselect_b32 s84, s84, s85
    s_add_u32 s84, s84, 14
    s_lshl_b32 s85, s32, 1
    s_add_u32 s85, s85, 0
    s_lshl_b32 s76, s85, 10
    s_mov_b32 s64, 0
    s_mov_b32 s40, s28
    s_mov_b32 s41, s29
    s_mov_b32 s42, 4194304
    s_mov_b32 s43, 0x00020000
    s_mov_b32 s70, 64
    s_lshl_b32 s82, s30, 19
    s_lshl_b32 s83, s85, 15
    s_add_u32 s82, s82, s83
    v_add_u32 v6, s82, v25
    s_lshl_b32 s85, s32, 1
    s_add_u32 s85, s85, 1
    s_lshl_b32 s77, s85, 10
    s_mov_b32 s65, 0
    s_mov_b32 s44, s28
    s_mov_b32 s45, s29
    s_mov_b32 s46, 4194304
    s_mov_b32 s47, 0x00020000
    s_mov_b32 s71, 64
    s_lshl_b32 s82, s30, 19
    s_lshl_b32 s83, s85, 15
    s_add_u32 s82, s82, s83
    v_add_u32 v7, s82, v25
    s_add_u32 s85, s84, 2
    s_lshl_b32 s78, s85, 10
    s_mov_b32 s66, 0
    s_mov_b32 s51, 0x00020000
    s_cmp_lt_u32 s85, 30
    s_cbranch_scc0 slotq_5
    s_cmp_lt_u32 s85, 23
    s_cselect_b32 s48, s12, s14
    s_cselect_b32 s49, s13, s15
    s_cselect_b32 s82, 16, 23
    s_sub_u32 s85, s85, s82
    s_mov_b32 s50, 7340032
    s_mov_b32 s72, 229376
    s_lshl_b32 s85, s85, 6
    v_add_u32 v20, s85, v1
    v_mul_u32_u24 v21, 4682, v20
    v_lshrrev_b32 v21, 16, v21
    v_mul_u32_u24 v22, 14, v21
    v_sub_u32 v22, v20, v22
    v_and_b32 v23, 0x13, v21
    v_and_b32 v24, 4, v21
    v_lshlrev_b32 v24, 1, v24
    v_or_b32 v23, v23, v24
    v_and_b32 v24, 8, v21
    v_lshrrev_b32 v24, 1, v24
    v_or_b32 v23, v23, v24
    v_mul_u32_u24 v23, 7168, v23
    v_lshlrev_b32 v22, 4, v22
    v_add_u32 v23, v23, v22
    v_add_u32 v8, s35, v23
    s_branch slote_6
slotq_5:
    s_mov_b32 s48, s16
    s_mov_b32 s49, s17
    s_mov_b32 s50, 6291456
    s_mov_b32 s72, 196608
    s_sub_u32 s85, s85, 30
    s_lshl_b32 s85, s85, 6
    v_add_u32 v20, s85, v1
    v_mul_u32_u24 v21, 5462, v20
    v_lshrrev_b32 v21, 16, v21
    v_mul_u32_u24 v22, 12, v21
    v_sub_u32 v22, v20, v22
    v_lshrrev_b32 v23, 3, v21
    v_and_b32 v23, 1, v23
    v_lshlrev_b32 v23, 1, v23
    v_xor_b32 v22, v22, v23
    v_lshrrev_b32 v23, 2, v22
    v_lshlrev_b32 v23, 11, v23
    v_and_b32 v22, 3, v22
    v_lshlrev_b32 v22, 4, v22
    v_mul_u32_u24 v21, 6144, v21
    v_add_u32 v21, v21, v23
    v_add_u32 v21, v21, v22
    v_add_u32 v8, s36, v21
slote_6:
    s_add_u32 s85, s84, 3
    s_lshl_b32 s79, s85, 10
    s_mov_b32 s67, 0
    s_mov_b32 s55, 0x00020000
    s_cmp_lt_u32 s85, 30
    s_cbranch_scc0 slotq_7
    s_cmp_lt_u32 s85, 23
    s_cselect_b32 s52, s12, s14
    s_cselect_b32 s53, s13, s15
    s_cselect_b32 s82, 16, 23
    s_sub_u32 s85, s85, s82
    s_mov_b32 s54, 7340032
    s_mov_b32 s73, 229376
    s_lshl_b32 s85, s85, 6
    v_add_u32 v20, s85, v1
    v_mul_u32_u24 v21, 4682, v20
    v_lshrrev_b32 v21, 16, v21
    v_mul_u32_u24 v22, 14, v21
    v_sub_u32 v22, v20, v22
    v_and_b32 v23, 0x13, v21
    v_and_b32 v24, 4, v21
    v_lshlrev_b32 v24, 1, v24
    v_or_b32 v23, v23, v24
    v_and_b32 v24, 8, v21
    v_lshrrev_b32 v24, 1, v24
    v_or_b32 v23, v23, v24
    v_mul_u32_u24 v23, 7168, v23
    v_lshlrev_b32 v22, 4, v22
    v_add_u32 v23, v23, v22
    v_add_u32 v9, s35, v23
    s_branch slote_8
slotq_7:
    s_mov_b32 s52, s16
    s_mov_b32 s53, s17
    s_mov_b32 s54, 6291456
    s_mov_b32 s73, 196608
    s_sub_u32 s85, s85, 30
    s_lshl_b32 s85, s85, 6
    v_add_u32 v20, s85, v1
    v_mul_u32_u24 v21, 5462, v20
    v_lshrrev_b32 v21, 16, v21
    v_mul_u32_u24 v22, 12, v21
    v_sub_u32 v22, v20, v22
    v_lshrrev_b32 v23, 3, v21
    v_and_b32 v23, 1, v23
    v_lshlrev_b32 v23, 1, v23
    v_xor_b32 v22, v22, v23
    v_lshrrev_b32 v23, 2, v22
    v_lshlrev_b32 v23, 11, v23
    v_and_b32 v22, 3, v22
    v_lshlrev_b32 v22, 4, v22
    v_mul_u32_u24 v21, 6144, v21
    v_add_u32 v21, v21, v23
    v_add_u32 v21, v21, v22
    v_add_u32 v9, s36, v21
slote_8:
    s_add_u32 s85, s84, 4
    s_lshl_b32 s80, s85, 10
    s_mov_b32 s68, 0
    s_mov_b32 s59, 0x00020000
    s_cmp_lt_u32 s85, 30
    s_cbranch_scc0 slotq_9
    s_cmp_lt_u32 s85, 23
    s_cselect_b32 s56, s12, s14
    s_cselect_b32 s57, s13, s15
    s_cselect_b32 s82, 16, 23
    s_sub_u32 s85, s85, s82
    s_mov_b32 s58, 7340032
    s_mov_b32 s74, 229376
    s_lshl_b32 s85, s85, 6
    v_add_u32 v20, s85, v1
    v_mul_u32_u24 v21, 4682, v20
    v_lshrrev_b32 v21, 16, v21
    v_mul_u32_u24 v22, 14, v21
    v_sub_u32 v22, v20, v22
    v_and_b32 v23, 0x13, v21
    v_and_b32 v24, 4, v21
    v_lshlrev_b32 v24, 1, v24
    v_or_b32 v23, v23, v24
    v_and_b32 v24, 8, v21
    v_lshrrev_b32 v24, 1, v24
    v_or_b32 v23, v23, v24
    v_mul_u32_u24 v23, 7168, v23
    v_lshlrev_b32 v22, 4, v22
    v_add_u32 v23, v23, v22
    v_add_u32 v10, s35, v23
    s_branch slote_10
slotq_9:
    s_mov_b32 s56, s16
    s_mov_b32 s57, s17
    s_mov_b32 s58, 6291456
    s_mov_b32 s74, 196608
    s_sub_u32 s85, s85, 30
    s_lshl_b32 s85, s85, 6
    v_add_u32 v20, s85, v1
    v_mul_u32_u24 v21, 5462, v20
    v_lshrrev_b32 v21, 16, v21
    v_mul_u32_u24 v22, 12, v21
    v_sub_u32 v22, v20, v22
    v_lshrrev_b32 v23, 3, v21
    v_and_b32 v23, 1, v23
    v_lshlrev_b32 v23, 1, v23
    v_xor_b32 v22, v22, v23
    v_lshrrev_b32 v23, 2, v22
    v_lshlrev_b32 v23, 11, v23
    v_and_b32 v22, 3, v22
    v_lshlrev_b32 v22, 4, v22
    v_mul_u32_u24 v21, 6144, v21
    v_add_u32 v21, v21, v23
    v_add_u32 v21, v21, v22
    v_add_u32 v10, s36, v21
slote_10:
    s_add_u32 m0, s37, s76
    s_nop 0
    buffer_load_dwordx4 v6, s[40:43], s64 offen lds
    s_add_u32 s64, s64, s70
    s_add_u32 m0, s37, s77
    s_nop 0
    buffer_load_dwordx4 v7, s[44:47], s65 offen lds
    s_add_u32 s65, s65, s71
    s_add_u32 m0, s37, s78
    s_nop 0
    buffer_load_dwordx4 v8, s[48:51], s66 offen lds
    s_add_u32 s66, s66, s72
    s_add_u32 m0, s37, s79
    s_nop 0
    buffer_load_dwordx4 v9, s[52:55], s67 offen lds
    s_add_u32 s67, s67, s73
    s_cmp_ge_u32 s32, 4
    s_cbranch_scc1 skip_11
    s_add_u32 m0, s37, s80
    s_nop 0
    buffer_load_dwordx4 v10, s[56:59], s68 offen lds
    s_add_u32 s68, s68, s74
skip_11:
    s_add_u32 s37, s37, 36864
    s_add_u32 m0, s37, s76
    s_nop 0
    buffer_load_dwordx4 v6, s[40:43], s64 offen lds
    s_add_u32 s64, s64, s70
    s_add_u32 m0, s37, s77
    s_nop 0
    buffer_load_dwordx4 v7, s[44:47], s65 offen lds
    s_add_u32 s65, s65, s71
    s_add_u32 m0, s37, s78
    s_nop 0
    buffer_load_dwordx4 v8, s[48:51], s66 offen lds
    s_add_u32 s66, s66, s72
    s_add_u32 m0, s37, s79
    s_nop 0
    buffer_load_dwordx4 v9, s[52:55], s67 offen lds
    s_add_u32 s67, s67, s73
    s_cmp_ge_u32 s32, 4
    s_cbranch_scc1 skip_12
    s_add_u32 m0, s37, s80
    s_nop 0
    buffer_load_dwordx4 v10, s[56:59], s68 offen lds
    s_add_u32 s68, s68, s74
skip_12:
    s_add_u32 s37, s37, 36864
    s_add_u32 m0, s37, s76
    s_nop 0
    buffer_load_dwordx4 v6, s[40:43], s64 offen lds
    s_add_u32 s64, s64, s70
    s_add_u32 m0, s37, s77
    s_nop 0
    buffer_load_dwordx4 v7, s[44:47], s65 offen lds
    s_add_u32 s65, s65, s71
    s_add_u32 m0, s37, s78
    s_nop 0
    buffer_load_dwordx4 v8, s[48:51], s66 offen lds
    s_add_u32 s66, s66, s72
    s_add_u32 m0, s37, s79
    s_nop 0
    buffer_load_dwordx4 v9, s[52:55], s67 offen lds
    s_add_u32 s67, s67, s73
    s_cmp_ge_u32 s32, 4
    s_cbranch_scc1 skip_13
    s_add_u32 m0, s37, s80
    s_nop 0
    buffer_load_dwordx4 v10, s[56:59], s68 offen lds
    s_add_u32 s68, s68, s74
skip_13:
    s_add_u32 s37, s37, 36864
    v_lshrrev_b32 v21, 1, v4
    v_and_b32 v22, 1, v4
    v_xor_b32 v22, v22, v21
    v_lshlrev_b32 v22, 1, v22
    v_or_b32 v22, v22, v21
    v_xor_b32 v22, v22, v2
    v_lshlrev_b32 v22, 4, v22
    s_lshl_b32 s82, s33, 12
    v_lshlrev_b32 v13, 6, v5
    v_add_u32 v13, v13, v22
    v_add_u32 v13, s82, v13
    v_lshrrev_b32 v21, 1, v2
    v_and_b32 v22, 1, v2
    v_lshlrev_b32 v15, 4, v21
    v_lshlrev_b32 v16, 2, v22
    v_add_u32 v15, v15, v16
    v_add_u32 v15, v15, v4
    v_mul_u32_u24 v15, 224, v15
    v_lshrrev_b32 v16, 1, v3
    v_lshlrev_b32 v16, 4, v16
    v_and_b32 v17, 1, v3
    v_lshlrev_b32 v17, 3, v17
    v_add_u32 v16, v16, v17
    v_add_u32 v15, v15, v16
    v_lshlrev_b32 v17, 3, v2
    v_add_u32 v17, v17, v4
    v_mul_u32_u24 v17, 192, v17
    v_add_u32 v17, v17, v16
    v_lshlrev_b32 v18, 5, v22
    v_sub_u32 v19, v17, v18
    v_add_u32 v17, v17, v18
    s_lshl_b32 s82, s2, 3
    s_add_u32 s82, s82, s32
    v_lshlrev_b32 v20, 11, v1
    v_add_u32 v20, s82, v20
    v_subrev_u32 v21, 5120, v20
    v_min_u32 v21, 2047, v21
    v_lshlrev_b32 v21, 11, v21
    v_add_u32 v21, 384, v21
    v_mov_b32 v84, 64
    v_mov_b32 v82, s28
    v_mov_b32 v83, s29
    v_subrev_u32 v22, 3584, v20
    v_lshlrev_b32 v22, 7, v22
    v_add_u32 v22, 1179648, v22
    v_cmp_gt_u32 vcc, 5120, v20
    v_mov_b32 v23, 196608
    v_mov_b32 v24, s16
    v_mov_b32 v25, s17
    v_cndmask_b32 v21, v21, v22, vcc
    v_cndmask_b32 v84, v84, v23, vcc
    v_cndmask_b32 v82, v82, v24, vcc
    v_cndmask_b32 v83, v83, v25, vcc
    v_subrev_u32 v22, 1792, v20
    v_lshlrev_b32 v22, 7, v22
    v_add_u32 v22, 1376256, v22
    v_cmp_gt_u32 vcc, 3584, v20
    v_mov_b32 v23, 229376
    v_mov_b32 v24, s14
    v_mov_b32 v25, s15
    v_cndmask_b32 v21, v21, v22, vcc
    v_cndmask_b32 v84, v84, v23, vcc
    v_cndmask_b32 v82, v82, v24, vcc
    v_cndmask_b32 v83, v83, v25, vcc
    v_lshlrev_b32 v22, 7, v20
    v_add_u32 v22, 1376256, v22
    v_cmp_gt_u32 vcc, 1792, v20
    v_mov_b32 v24, s12
    v_mov_b32 v25, s13
    s_nop 0
    v_cndmask_b32 v21, v21, v22, vcc
    v_cndmask_b32 v82, v82, v24, vcc
    v_cndmask_b32 v83, v83, v25, vcc
    v_add_co_u32 v82, vcc, v82, v21
    s_nop 1
    v_addc_co_u32 v83, vcc, 0, v83, vcc
    s_mov_b64 exec, 15
    global_load_dword v85, v[82:83], off
    global_load_dword v85, v[82:83], off
    s_mov_b64 exec, -1
    v_mov_b32 v96, 0
    v_mov_b32 v97, 0
    v_mov_b32 v98, 0
    v_mov_b32 v99, 0
    v_mov_b32 v100, 0
    v_mov_b32 v101, 0
    v_mov_b32 v102, 0
    v_mov_b32 v103, 0
    v_mov_b32 v104, 0
    v_mov_b32 v105, 0
    v_mov_b32 v106, 0
    v_mov_b32 v107, 0
    v_mov_b32 v108, 0
    v_mov_b32 v109, 0
    v_mov_b32 v110, 0
    v_mov_b32 v111, 0
    v_mov_b32 v112, 0
    v_mov_b32 v113, 0
    v_mov_b32 v114, 0
    v_mov_b32 v115, 0
    v_mov_b32 v116, 0
    v_mov_b32 v117, 0
    v_mov_b32 v118, 0
    v_mov_b32 v119, 0
    v_mov_b32 v120, 0
    v_mov_b32 v121, 0
    v_mov_b32 v122, 0
    v_mov_b32 v123, 0
    v_mov_b32 v124, 0
    v_mov_b32 v125, 0
    v_mov_b32 v126, 0
    v_mov_b32 v127, 0
    v_mov_b32 v128, 0
    v_mov_b32 v129, 0
    v_mov_b32 v130, 0
    v_mov_b32 v131, 0
    v_mov_b32 v132, 0
    v_mov_b32 v133, 0
    v_mov_b32 v134, 0
    v_mov_b32 v135, 0
    v_mov_b32 v136, 0
    v_mov_b32 v137, 0
    v_mov_b32 v138, 0
    v_mov_b32 v139, 0
    v_mov_b32 v140, 0
    v_mov_b32 v141, 0
    v_mov_b32 v142, 0
    v_mov_b32 v143, 0
    v_mov_b32 v144, 0
    v_mov_b32 v145, 0
    v_mov_b32 v146, 0
    v_mov_b32 v147, 0
    v_mov_b32 v148, 0
    v_mov_b32 v149, 0
    v_mov_b32 v150, 0
    v_mov_b32 v151, 0
    v_mov_b32 v152, 0
    v_mov_b32 v153, 0
    v_mov_b32 v154, 0
    v_mov_b32 v155, 0
    v_mov_b32 v156, 0
    v_mov_b32 v157, 0
    v_mov_b32 v158, 0
    v_mov_b32 v159, 0
    v_mov_b32 v160, 0
    v_mov_b32 v161, 0
    v_mov_b32 v162, 0
    v_mov_b32 v163, 0
    v_mov_b32 v164, 0
    v_mov_b32 v165, 0
    v_mov_b32 v166, 0
    v_mov_b32 v167, 0
    v_mov_b32 v168, 0
    v_mov_b32 v169, 0
    v_mov_b32 v170, 0
    v_mov_b32 v171, 0
    v_mov_b32 v172, 0
    v_mov_b32 v173, 0
    v_mov_b32 v174, 0
    v_mov_b32 v175, 0
    v_mov_b32 v176, 0
    v_mov_b32 v177, 0
    v_mov_b32 v178, 0
    v_mov_b32 v179, 0
    v_mov_b32 v180, 0
    v_mov_b32 v181, 0
    v_mov_b32 v182, 0
    v_mov_b32 v183, 0
    v_mov_b32 v184, 0
    v_mov_b32 v185, 0
    v_mov_b32 v186, 0
    v_mov_b32 v187, 0
    v_mov_b32 v188, 0
    v_mov_b32 v189, 0
    v_mov_b32 v190, 0
    v_mov_b32 v191, 0
    v_mov_b32 v192, 0
    v_mov_b32 v193, 0
    v_mov_b32 v194, 0
    v_mov_b32 v195, 0
    v_mov_b32 v196, 0
    v_mov_b32 v197, 0
    v_mov_b32 v198, 0
    v_mov_b32 v199, 0
    v_mov_b32 v200, 0
    v_mov_b32 v201, 0
    v_mov_b32 v202, 0
    v_mov_b32 v203, 0
    v_mov_b32 v204, 0
    v_mov_b32 v205, 0
    v_mov_b32 v206, 0
    v_mov_b32 v207, 0
    v_mov_b32 v208, 0
    v_mov_b32 v209, 0
    v_mov_b32 v210, 0
    v_mov_b32 v211, 0
    v_mov_b32 v212, 0
    v_mov_b32 v213, 0
    v_mov_b32 v214, 0
    v_mov_b32 v215, 0
    v_mov_b32 v216, 0
    v_mov_b32 v217, 0
    v_mov_b32 v218, 0
    v_mov_b32 v219, 0
    v_mov_b32 v220, 0
    v_mov_b32 v221, 0
    v_mov_b32 v222, 0
    v_mov_b32 v223, 0
    v_mov_b32 v224, 0
    v_mov_b32 v225, 0
    v_mov_b32 v226, 0
    v_mov_b32 v227, 0
    v_mov_b32 v228, 0
    v_mov_b32 v229, 0
    v_mov_b32 v230, 0
    v_mov_b32 v231, 0
    v_mov_b32 v232, 0
    v_mov_b32 v233, 0
    v_mov_b32 v234, 0
    v_mov_b32 v235, 0
    v_mov_b32 v236, 0
    v_mov_b32 v237, 0
    v_mov_b32 v238, 0
    v_mov_b32 v239, 0
    v_mov_b32 v240, 0
    v_mov_b32 v241, 0
    v_mov_b32 v242, 0
    v_mov_b32 v243, 0
    v_mov_b32 v244, 0
    v_mov_b32 v245, 0
    v_mov_b32 v246, 0
    v_mov_b32 v247, 0
    v_mov_b32 v248, 0
    v_mov_b32 v249, 0
    v_mov_b32 v250, 0
    v_mov_b32 v251, 0
    v_mov_b32 v252, 0
    v_mov_b32 v253, 0
    v_mov_b32 v254, 0
    v_mov_b32 v255, 0
    s_waitcnt vmcnt(10)
    s_barrier
    s_cmp_eq_u32 s34, 0
    s_cbranch_scc0 k1_kernel_wn1
    v_add_u32 v14, s38, v13
    v_add_u32 v16, s38, v15
    s_add_u32 s38, s38, 36864
    s_cmp_eq_u32 s38, 147456
    s_cselect_b32 s38, 0, s38
    ds_read_b128 v[32:35], v14 offset:0
    ds_read_b128 v[36:39], v14 offset:1024
    ds_read_b128 v[40:43], v14 offset:2048
    ds_read_b128 v[44:47], v14 offset:3072
    ds_read_b64_tr_b16 v[64:65], v16 offset:16384
    ds_read_b64_tr_b16 v[66:67], v16 offset:18176
    ds_read_b64_tr_b16 v[68:69], v16 offset:16416
    ds_read_b64_tr_b16 v[70:71], v16 offset:18208
    s_mov_b32 s39, 14
k1_kernel_loop0:
    s_waitcnt vmcnt(7)
    s_barrier
    ds_read_b64_tr_b16 v[72:73], v16 offset:16448
    ds_read_b64_tr_b16 v[74:75], v16 offset:18240
    s_waitcnt lgkmcnt(4)
    v_mfma_f32_16x16x32_bf16 v[96:99], v[64:67], v[32:35], v[96:99]
    v_mfma_f32_16x16x32_bf16 v[100:103], v[64:67], v[36:39], v[100:103]
    v_mfma_f32_16x16x32_bf16 v[104:107], v[64:67], v[40:43], v[104:107]
    v_mfma_f32_16x16x32_bf16 v[108:111], v[64:67], v[44:47], v[108:111]
    s_add_u32 m0, s37, s76
    s_nop 0
    buffer_load_dwordx4 v6, s[40:43], s64 offen lds
    s_add_u32 s64, s64, s70
    ds_read_b64_tr_b16 v[76:77], v16 offset:16480
    ds_read_b64_tr_b16 v[78:79], v16 offset:18272
    s_waitcnt lgkmcnt(4)
    v_mfma_f32_16x16x32_bf16 v[112:115], v[68:71], v[32:35], v[112:115]
    v_mfma_f32_16x16x32_bf16 v[116:119], v[68:71], v[36:39], v[116:119]
    v_mfma_f32_16x16x32_bf16 v[120:123], v[68:71], v[40:43], v[120:123]
    v_mfma_f32_16x16x32_bf16 v[124:127], v[68:71], v[44:47], v[124:127]
    s_add_u32 m0, s37, s77
    s_nop 0
    buffer_load_dwordx4 v7, s[44:47], s65 offen lds
    s_add_u32 s65, s65, s71
    ds_read_b64_tr_b16 v[64:65], v16 offset:16512
    ds_read_b64_tr_b16 v[66:67], v16 offset:18304
    s_waitcnt lgkmcnt(4)
    v_mfma_f32_16x16x32_bf16 v[128:131], v[72:75], v[32:35], v[128:131]
    v_mfma_f32_16x16x32_bf16 v[132:135], v[72:75], v[36:39], v[132:135]
    v_mfma_f32_16x16x32_bf16 v[136:139], v[72:75], v[40:43], v[136:139]
    v_mfma_f32_16x16x32_bf16 v[140:143], v[72:75], v[44:47], v[140:143]
    s_add_u32 m0, s37, s78
    s_nop 0
    buffer_load_dwordx4 v8, s[48:51], s66 offen lds
    s_add_u32 s66, s66, s72
    ds_read_b64_tr_b16 v[68:69], v16 offset:23552
    ds_read_b64_tr_b16 v[70:71], v16 offset:25344
    s_waitcnt lgkmcnt(4)
    v_mfma_f32_16x16x32_bf16 v[144:147], v[76:79], v[32:35], v[144:147]
    v_mfma_f32_16x16x32_bf16 v[148:151], v[76:79], v[36:39], v[148:151]
    v_mfma_f32_16x16x32_bf16 v[152:155], v[76:79], v[40:43], v[152:155]
    v_mfma_f32_16x16x32_bf16 v[156:159], v[76:79], v[44:47], v[156:159]
    s_add_u32 m0, s37, s79
    s_nop 0
    buffer_load_dwordx4 v9, s[52:55], s67 offen lds
    s_add_u32 s67, s67, s73
    ds_read_b64_tr_b16 v[72:73], v16 offset:23584
    ds_read_b64_tr_b16 v[74:75], v16 offset:25376
    s_waitcnt lgkmcnt(4)
    v_mfma_f32_16x16x32_bf16 v[160:163], v[64:67], v[32:35], v[160:163]
    v_mfma_f32_16x16x32_bf16 v[164:167], v[64:67], v[36:39], v[164:167]
    v_mfma_f32_16x16x32_bf16 v[168:171], v[64:67], v[40:43], v[168:171]
    v_mfma_f32_16x16x32_bf16 v[172:175], v[64:67], v[44:47], v[172:175]
    s_add_u32 m0, s37, s80
    s_nop 0
    buffer_load_dwordx4 v10, s[56:59], s68 offen lds
    s_add_u32 s68, s68, s74
    s_add_u32 s37, s37, 36864
    s_cmp_eq_u32 s37, 147456
    s_cselect_b32 s37, 0, s37
    s_mov_b64 exec, 15
    global_load_dword v85, v[82:83], off
    s_cmp_lt_u32 s39, 2
    s_cbranch_scc1 nt_14
    v_add_co_u32 v82, vcc, v82, v84
    s_nop 1
    v_addc_co_u32 v83, vcc, 0, v83, vcc
nt_14:
    s_mov_b64 exec, -1
    ds_read_b64_tr_b16 v[76:77], v16 offset:23616
    ds_read_b64_tr_b16 v[78:79], v16 offset:25408
    s_waitcnt lgkmcnt(4)
    v_mfma_f32_16x16x32_bf16 v[176:179], v[68:71], v[32:35], v[176:179]
    v_mfma_f32_16x16x32_bf16 v[180:183], v[68:71], v[36:39], v[180:183]
    v_mfma_f32_16x16x32_bf16 v[184:187], v[68:71], v[40:43], v[184:187]
    v_mfma_f32_16x16x32_bf16 v[188:191], v[68:71], v[44:47], v[188:191]
    ds_read_b64_tr_b16 v[64:65], v16 offset:23648
    ds_read_b64_tr_b16 v[66:67], v16 offset:25440
    s_waitcnt lgkmcnt(4)
    v_mfma_f32_16x16x32_bf16 v[192:195], v[72:75], v[32:35], v[192:195]
    v_mfma_f32_16x16x32_bf16 v[196:199], v[72:75], v[36:39], v[196:199]
    v_mfma_f32_16x16x32_bf16 v[200:203], v[72:75], v[40:43], v[200:203]
    v_mfma_f32_16x16x32_bf16 v[204:207], v[72:75], v[44:47], v[204:207]
    ds_read_b64_tr_b16 v[68:69], v16 offset:23680
    ds_read_b64_tr_b16 v[70:71], v16 offset:25472
    s_waitcnt lgkmcnt(4)
    v_mfma_f32_16x16x32_bf16 v[208:211], v[76:79], v[32:35], v[208:211]
    v_mfma_f32_16x16x32_bf16 v[212:215], v[76:79], v[36:39], v[212:215]
    v_mfma_f32_16x16x32_bf16 v[216:219], v[76:79], v[40:43], v[216:219]
    v_mfma_f32_16x16x32_bf16 v[220:223], v[76:79], v[44:47], v[220:223]
    v_add_u32 v14, s38, v13
    v_add_u32 v16, s38, v15
    s_add_u32 s38, s38, 36864
    s_cmp_eq_u32 s38, 147456
    s_cselect_b32 s38, 0, s38
    ds_read_b128 v[48:51], v14 offset:0
    ds_read_b128 v[52:55], v14 offset:1024
    ds_read_b128 v[56:59], v14 offset:2048
    ds_read_b128 v[60:63], v14 offset:3072
    ds_read_b64_tr_b16 v[72:73], v16 offset:16384
    ds_read_b64_tr_b16 v[74:75], v16 offset:18176
    s_waitcnt lgkmcnt(8)
    v_mfma_f32_16x16x32_bf16 v[224:227], v[64:67], v[32:35], v[224:227]
    v_mfma_f32_16x16x32_bf16 v[228:231], v[64:67], v[36:39], v[228:231]
    v_mfma_f32_16x16x32_bf16 v[232:235], v[64:67], v[40:43], v[232:235]
    v_mfma_f32_16x16x32_bf16 v[236:239], v[64:67], v[44:47], v[236:239]
    ds_read_b64_tr_b16 v[76:77], v16 offset:16416
    ds_read_b64_tr_b16 v[78:79], v16 offset:18208
    s_waitcnt lgkmcnt(8)
    v_mfma_f32_16x16x32_bf16 v[240:243], v[68:71], v[32:35], v[240:243]
    v_mfma_f32_16x16x32_bf16 v[244:247], v[68:71], v[36:39], v[244:247]
    v_mfma_f32_16x16x32_bf16 v[248:251], v[68:71], v[40:43], v[248:251]
    v_mfma_f32_16x16x32_bf16 v[252:255], v[68:71], v[44:47], v[252:255]
    s_waitcnt vmcnt(7)
    s_barrier
    ds_read_b64_tr_b16 v[64:65], v16 offset:16448
    ds_read_b64_tr_b16 v[66:67], v16 offset:18240
    s_waitcnt lgkmcnt(4)
    v_mfma_f32_16x16x32_bf16 v[96:99], v[72:75], v[48:51], v[96:99]
    v_mfma_f32_16x16x32_bf16 v[100:103], v[72:75], v[52:55], v[100:103]
    v_mfma_f32_16x16x32_bf16 v[104:107], v[72:75], v[56:59], v[104:107]
    v_mfma_f32_16x16x32_bf16 v[108:111], v[72:75], v[60:63], v[108:111]
    s_add_u32 m0, s37, s76
    s_nop 0
    buffer_load_dwordx4 v6, s[40:43], s64 offen lds
    s_add_u32 s64, s64, s70
    ds_read_b64_tr_b16 v[68:69], v16 offset:16480
    ds_read_b64_tr_b16 v[70:71], v16 offset:18272
    s_waitcnt lgkmcnt(4)
    v_mfma_f32_16x16x32_bf16 v[112:115], v[76:79], v[48:51], v[112:115]
    v_mfma_f32_16x16x32_bf16 v[116:119], v[76:79], v[52:55], v[116:119]
    v_mfma_f32_16x16x32_bf16 v[120:123], v[76:79], v[56:59], v[120:123]
    v_mfma_f32_16x16x32_bf16 v[124:127], v[76:79], v[60:63], v[124:127]
    s_add_u32 m0, s37, s77
    s_nop 0
    buffer_load_dwordx4 v7, s[44:47], s65 offen lds
    s_add_u32 s65, s65, s71
    ds_read_b64_tr_b16 v[72:73], v16 offset:16512
    ds_read_b64_tr_b16 v[74:75], v16 offset:18304
    s_waitcnt lgkmcnt(4)
    v_mfma_f32_16x16x32_bf16 v[128:131], v[64:67], v[48:51], v[128:131]
    v_mfma_f32_16x16x32_bf16 v[132:135], v[64:67], v[52:55], v[132:135]
    v_mfma_f32_16x16x32_bf16 v[136:139], v[64:67], v[56:59], v[136:139]
    v_mfma_f32_16x16x32_bf16 v[140:143], v[64:67], v[60:63], v[140:143]
    s_add_u32 m0, s37, s78
    s_nop 0
    buffer_load_dwordx4 v8, s[48:51], s66 offen lds
    s_add_u32 s66, s66, s72
    ds_read_b64_tr_b16 v[76:77], v16 offset:23552
    ds_read_b64_tr_b16 v[78:79], v16 offset:25344
    s_waitcnt lgkmcnt(4)
    v_mfma_f32_16x16x32_bf16 v[144:147], v[68:71], v[48:51], v[144:147]
    v_mfma_f32_16x16x32_bf16 v[148:151], v[68:71], v[52:55], v[148:151]
    v_mfma_f32_16x16x32_bf16 v[152:155], v[68:71], v[56:59], v[152:155]
    v_mfma_f32_16x16x32_bf16 v[156:159], v[68:71], v[60:63], v[156:159]
    s_add_u32 m0, s37, s79
    s_nop 0
    buffer_load_dwordx4 v9, s[52:55], s67 offen lds
    s_add_u32 s67, s67, s73
    ds_read_b64_tr_b16 v[64:65], v16 offset:23584
    ds_read_b64_tr_b16 v[66:67], v16 offset:25376
    s_waitcnt lgkmcnt(4)
    v_mfma_f32_16x16x32_bf16 v[160:163], v[72:75], v[48:51], v[160:163]
    v_mfma_f32_16x16x32_bf16 v[164:167], v[72:75], v[52:55], v[164:167]
    v_mfma_f32_16x16x32_bf16 v[168:171], v[72:75], v[56:59], v[168:171]
    v_mfma_f32_16x16x32_bf16 v[172:175], v[72:75], v[60:63], v[172:175]
    s_add_u32 m0, s37, s80
    s_nop 0
    buffer_load_dwordx4 v10, s[56:59], s68 offen lds
    s_add_u32 s68, s68, s74
    s_add_u32 s37, s37, 36864
    s_cmp_eq_u32 s37, 147456
    s_cselect_b32 s37, 0, s37
    s_mov_b64 exec, 15
    global_load_dword v85, v[82:83], off
    s_cmp_lt_u32 s39, 3
    s_cbranch_scc1 nt_15
    v_add_co_u32 v82, vcc, v82, v84
    s_nop 1
    v_addc_co_u32 v83, vcc, 0, v83, vcc
nt_15:
    s_mov_b64 exec, -1
    ds_read_b64_tr_b16 v[68:69], v16 offset:23616
    ds_read_b64_tr_b16 v[70:71], v16 offset:25408
    s_waitcnt lgkmcnt(4)
    v_mfma_f32_16x16x32_bf16 v[176:179], v[76:79], v[48:51], v[176:179]
    v_mfma_f32_16x16x32_bf16 v[180:183], v[76:79], v[52:55], v[180:183]
    v_mfma_f32_16x16x32_bf16 v[184:187], v[76:79], v[56:59], v[184:187]
    v_mfma_f32_16x16x32_bf16 v[188:191], v[76:79], v[60:63], v[188:191]
    ds_read_b64_tr_b16 v[72:73], v16 offset:23648
    ds_read_b64_tr_b16 v[74:75], v16 offset:25440
    s_waitcnt lgkmcnt(4)
    v_mfma_f32_16x16x32_bf16 v[192:195], v[64:67], v[48:51], v[192:195]
    v_mfma_f32_16x16x32_bf16 v[196:199], v[64:67], v[52:55], v[196:199]
    v_mfma_f32_16x16x32_bf16 v[200:203], v[64:67], v[56:59], v[200:203]
    v_mfma_f32_16x16x32_bf16 v[204:207], v[64:67], v[60:63], v[204:207]
    ds_read_b64_tr_b16 v[76:77], v16 offset:23680
    ds_read_b64_tr_b16 v[78:79], v16 offset:25472
    s_waitcnt lgkmcnt(4)
    v_mfma_f32_16x16x32_bf16 v[208:211], v[68:71], v[48:51], v[208:211]
    v_mfma_f32_16x16x32_bf16 v[212:215], v[68:71], v[52:55], v[212:215]
    v_mfma_f32_16x16x32_bf16 v[216:219], v[68:71], v[56:59], v[216:219]
    v_mfma_f32_16x16x32_bf16 v[220:223], v[68:71], v[60:63], v[220:223]
    v_add_u32 v14, s38, v13
    v_add_u32 v16, s38, v15
    s_add_u32 s38, s38, 36864
    s_cmp_eq_u32 s38, 147456
    s_cselect_b32 s38, 0, s38
    ds_read_b128 v[32:35], v14 offset:0
    ds_read_b128 v[36:39], v14 offset:1024
    ds_read_b128 v[40:43], v14 offset:2048
    ds_read_b128 v[44:47], v14 offset:3072
    ds_read_b64_tr_b16 v[64:65], v16 offset:16384
    ds_read_b64_tr_b16 v[66:67], v16 offset:18176
    s_waitcnt lgkmcnt(8)
    v_mfma_f32_16x16x32_bf16 v[224:227], v[72:75], v[48:51], v[224:227]
    v_mfma_f32_16x16x32_bf16 v[228:231], v[72:75], v[52:55], v[228:231]
    v_mfma_f32_16x16x32_bf16 v[232:235], v[72:75], v[56:59], v[232:235]
    v_mfma_f32_16x16x32_bf16 v[236:239], v[72:75], v[60:63], v[236:239]
    ds_read_b64_tr_b16 v[68:69], v16 offset:16416
    ds_read_b64_tr_b16 v[70:71], v16 offset:18208
    s_waitcnt lgkmcnt(8)
    v_mfma_f32_16x16x32_bf16 v[240:243], v[76:79], v[48:51], v[240:243]
    v_mfma_f32_16x16x32_bf16 v[244:247], v[76:79], v[52:55], v[244:247]
    v_mfma_f32_16x16x32_bf16 v[248:251], v[76:79], v[56:59], v[248:251]
    v_mfma_f32_16x16x32_bf16 v[252:255], v[76:79], v[60:63], v[252:255]
    s_sub_u32 s39, s39, 1
    s_cmp_lg_u32 s39, 0
    s_cbranch_scc1 k1_kernel_loop0
    s_waitcnt vmcnt(7)
    s_barrier
    ds_read_b64_tr_b16 v[72:73], v16 offset:16448
    ds_read_b64_tr_b16 v[74:75], v16 offset:18240
    s_waitcnt lgkmcnt(4)
    v_mfma_f32_16x16x32_bf16 v[96:99], v[64:67], v[32:35], v[96:99]
    v_mfma_f32_16x16x32_bf16 v[100:103], v[64:67], v[36:39], v[100:103]
    v_mfma_f32_16x16x32_bf16 v[104:107], v[64:67], v[40:43], v[104:107]
    v_mfma_f32_16x16x32_bf16 v[108:111], v[64:67], v[44:47], v[108:111]
    s_add_u32 m0, s37, s76
    s_nop 0
    buffer_load_dwordx4 v6, s[40:43], s64 offen lds
    s_add_u32 s64, s64, s70
    ds_read_b64_tr_b16 v[76:77], v16 offset:16480
    ds_read_b64_tr_b16 v[78:79], v16 offset:18272
    s_waitcnt lgkmcnt(4)
    v_mfma_f32_16x16x32_bf16 v[112:115], v[68:71], v[32:35], v[112:115]
    v_mfma_f32_16x16x32_bf16 v[116:119], v[68:71], v[36:39], v[116:119]
    v_mfma_f32_16x16x32_bf16 v[120:123], v[68:71], v[40:43], v[120:123]
    v_mfma_f32_16x16x32_bf16 v[124:127], v[68:71], v[44:47], v[124:127]
    s_add_u32 m0, s37, s77
    s_nop 0
    buffer_load_dwordx4 v7, s[44:47], s65 offen lds
    s_add_u32 s65, s65, s71
    ds_read_b64_tr_b16 v[64:65], v16 offset:16512
    ds_read_b64_tr_b16 v[66:67], v16 offset:18304
    s_waitcnt lgkmcnt(4)
    v_mfma_f32_16x16x32_bf16 v[128:131], v[72:75], v[32:35], v[128:131]
    v_mfma_f32_16x16x32_bf16 v[132:135], v[72:75], v[36:39], v[132:135]
    v_mfma_f32_16x16x32_bf16 v[136:139], v[72:75], v[40:43], v[136:139]
    v_mfma_f32_16x16x32_bf16 v[140:143], v[72:75], v[44:47], v[140:143]
    s_add_u32 m0, s37, s78
    s_nop 0
    buffer_load_dwordx4 v8, s[48:51], s66 offen lds
    s_add_u32 s66, s66, s72
    ds_read_b64_tr_b16 v[68:69], v16 offset:23552
    ds_read_b64_tr_b16 v[70:71], v16 offset:25344
    s_waitcnt lgkmcnt(4)
    v_mfma_f32_16x16x32_bf16 v[144:147], v[76:79], v[32:35], v[144:147]
    v_mfma_f32_16x16x32_bf16 v[148:151], v[76:79], v[36:39], v[148:151]
    v_mfma_f32_16x16x32_bf16 v[152:155], v[76:79], v[40:43], v[152:155]
    v_mfma_f32_16x16x32_bf16 v[156:159], v[76:79], v[44:47], v[156:159]
    s_add_u32 m0, s37, s79
    s_nop 0
    buffer_load_dwordx4 v9, s[52:55], s67 offen lds
    s_add_u32 s67, s67, s73
    ds_read_b64_tr_b16 v[72:73], v16 offset:23584
    ds_read_b64_tr_b16 v[74:75], v16 offset:25376
    s_waitcnt lgkmcnt(4)
    v_mfma_f32_16x16x32_bf16 v[160:163], v[64:67], v[32:35], v[160:163]
    v_mfma_f32_16x16x32_bf16 v[164:167], v[64:67], v[36:39], v[164:167]
    v_mfma_f32_16x16x32_bf16 v[168:171], v[64:67], v[40:43], v[168:171]
    v_mfma_f32_16x16x32_bf16 v[172:175], v[64:67], v[44:47], v[172:175]
    s_add_u32 m0, s37, s80
    s_nop 0
    buffer_load_dwordx4 v10, s[56:59], s68 offen lds
    s_add_u32 s68, s68, s74
    s_add_u32 s37, s37, 36864
    s_cmp_eq_u32 s37, 147456
    s_cselect_b32 s37, 0, s37
    ds_read_b64_tr_b16 v[76:77], v16 offset:23616
    ds_read_b64_tr_b16 v[78:79], v16 offset:25408
    s_waitcnt lgkmcnt(4)
    v_mfma_f32_16x16x32_bf16 v[176:179], v[68:71], v[32:35], v[176:179]
    v_mfma_f32_16x16x32_bf16 v[180:183], v[68:71], v[36:39], v[180:183]
    v_mfma_f32_16x16x32_bf16 v[184:187], v[68:71], v[40:43], v[184:187]
    v_mfma_f32_16x16x32_bf16 v[188:191], v[68:71], v[44:47], v[188:191]
    ds_read_b64_tr_b16 v[64:65], v16 offset:23648
    ds_read_b64_tr_b16 v[66:67], v16 offset:25440
    s_waitcnt lgkmcnt(4)
    v_mfma_f32_16x16x32_bf16 v[192:195], v[72:75], v[32:35], v[192:195]
    v_mfma_f32_16x16x32_bf16 v[196:199], v[72:75], v[36:39], v[196:199]
    v_mfma_f32_16x16x32_bf16 v[200:203], v[72:75], v[40:43], v[200:203]
    v_mfma_f32_16x16x32_bf16 v[204:207], v[72:75], v[44:47], v[204:207]
    ds_read_b64_tr_b16 v[68:69], v16 offset:23680
    ds_read_b64_tr_b16 v[70:71], v16 offset:25472
    s_waitcnt lgkmcnt(4)
    v_mfma_f32_16x16x32_bf16 v[208:211], v[76:79], v[32:35], v[208:211]
    v_mfma_f32_16x16x32_bf16 v[212:215], v[76:79], v[36:39], v[212:215]
    v_mfma_f32_16x16x32_bf16 v[216:219], v[76:79], v[40:43], v[216:219]
    v_mfma_f32_16x16x32_bf16 v[220:223], v[76:79], v[44:47], v[220:223]
    v_add_u32 v14, s38, v13
    v_add_u32 v16, s38, v15
    s_add_u32 s38, s38, 36864
    s_cmp_eq_u32 s38, 147456
    s_cselect_b32 s38, 0, s38
    ds_read_b128 v[48:51], v14 offset:0
    ds_read_b128 v[52:55], v14 offset:1024
    ds_read_b128 v[56:59], v14 offset:2048
    ds_read_b128 v[60:63], v14 offset:3072
    ds_read_b64_tr_b16 v[72:73], v16 offset:16384
    ds_read_b64_tr_b16 v[74:75], v16 offset:18176
    s_waitcnt lgkmcnt(8)
    v_mfma_f32_16x16x32_bf16 v[224:227], v[64:67], v[32:35], v[224:227]
    v_mfma_f32_16x16x32_bf16 v[228:231], v[64:67], v[36:39], v[228:231]
    v_mfma_f32_16x16x32_bf16 v[232:235], v[64:67], v[40:43], v[232:235]
    v_mfma_f32_16x16x32_bf16 v[236:239], v[64:67], v[44:47], v[236:239]
    ds_read_b64_tr_b16 v[76:77], v16 offset:16416
    ds_read_b64_tr_b16 v[78:79], v16 offset:18208
    s_waitcnt lgkmcnt(8)
    v_mfma_f32_16x16x32_bf16 v[240:243], v[68:71], v[32:35], v[240:243]
    v_mfma_f32_16x16x32_bf16 v[244:247], v[68:71], v[36:39], v[244:247]
    v_mfma_f32_16x16x32_bf16 v[248:251], v[68:71], v[40:43], v[248:251]
    v_mfma_f32_16x16x32_bf16 v[252:255], v[68:71], v[44:47], v[252:255]
    s_waitcnt vmcnt(6)
    s_barrier
    ds_read_b64_tr_b16 v[64:65], v16 offset:16448
    ds_read_b64_tr_b16 v[66:67], v16 offset:18240
    s_waitcnt lgkmcnt(4)
    v_mfma_f32_16x16x32_bf16 v[96:99], v[72:75], v[48:51], v[96:99]
    v_mfma_f32_16x16x32_bf16 v[100:103], v[72:75], v[52:55], v[100:103]
    v_mfma_f32_16x16x32_bf16 v[104:107], v[72:75], v[56:59], v[104:107]
    v_mfma_f32_16x16x32_bf16 v[108:111], v[72:75], v[60:63], v[108:111]
    s_lshl_b32 s82, s2, 3
    s_add_u32 s82, s82, s32
    s_lshl_b32 s82, s82, 10
    v_lshlrev_b32 v80, 4, v1
    v_add_u32 v80, s82, v80
    s_mov_b32 s40, s26
    s_mov_b32 s41, s27
    s_mov_b32 s42, 7340032
    s_mov_b32 s44, s24
    s_mov_b32 s45, s25
    s_mov_b32 s46, 2097152
    s_mov_b32 s82, 0
    buffer_load_dwordx4 v[84:87], v80, s[40:43], s82 offen
    s_add_u32 s82, s82, 0x200000
    ds_read_b64_tr_b16 v[68:69], v16 offset:16480
    ds_read_b64_tr_b16 v[70:71], v16 offset:18272
    s_waitcnt lgkmcnt(4)
    v_mfma_f32_16x16x32_bf16 v[112:115], v[76:79], v[48:51], v[112:115]
    v_mfma_f32_16x16x32_bf16 v[116:119], v[76:79], v[52:55], v[116:119]
    v_mfma_f32_16x16x32_bf16 v[120:123], v[76:79], v[56:59], v[120:123]
    v_mfma_f32_16x16x32_bf16 v[124:127], v[76:79], v[60:63], v[124:127]
    buffer_load_dwordx4 v[84:87], v80, s[40:43], s82 offen
    s_add_u32 s82, s82, 0x200000
    ds_read_b64_tr_b16 v[72:73], v16 offset:16512
    ds_read_b64_tr_b16 v[74:75], v16 offset:18304
    s_waitcnt lgkmcnt(4)
    v_mfma_f32_16x16x32_bf16 v[128:131], v[64:67], v[48:51], v[128:131]
    v_mfma_f32_16x16x32_bf16 v[132:135], v[64:67], v[52:55], v[132:135]
    v_mfma_f32_16x16x32_bf16 v[136:139], v[64:67], v[56:59], v[136:139]
    v_mfma_f32_16x16x32_bf16 v[140:143], v[64:67], v[60:63], v[140:143]
    buffer_load_dwordx4 v[84:87], v80, s[40:43], s82 offen
    s_add_u32 s82, s82, 0x200000
    ds_read_b64_tr_b16 v[76:77], v16 offset:23552
    ds_read_b64_tr_b16 v[78:79], v16 offset:25344
    s_waitcnt lgkmcnt(4)
    v_mfma_f32_16x16x32_bf16 v[144:147], v[68:71], v[48:51], v[144:147]
    v_mfma_f32_16x16x32_bf16 v[148:151], v[68:71], v[52:55], v[148:151]
    v_mfma_f32_16x16x32_bf16 v[152:155], v[68:71], v[56:59], v[152:155]
    v_mfma_f32_16x16x32_bf16 v[156:159], v[68:71], v[60:63], v[156:159]
    buffer_load_dwordx4 v[84:87], v80, s[40:43], s82 offen
    s_add_u32 s82, s82, 0x200000
    ds_read_b64_tr_b16 v[64:65], v16 offset:23584
    ds_read_b64_tr_b16 v[66:67], v16 offset:25376
    s_waitcnt lgkmcnt(4)
    v_mfma_f32_16x16x32_bf16 v[160:163], v[72:75], v[48:51], v[160:163]
    v_mfma_f32_16x16x32_bf16 v[164:167], v[72:75], v[52:55], v[164:167]
    v_mfma_f32_16x16x32_bf16 v[168:171], v[72:75], v[56:59], v[168:171]
    v_mfma_f32_16x16x32_bf16 v[172:175], v[72:75], v[60:63], v[172:175]
    buffer_load_dwordx4 v[84:87], v80, s[44:47], 0 offen
    ds_read_b64_tr_b16 v[68:69], v16 offset:23616
    ds_read_b64_tr_b16 v[70:71], v16 offset:25408
    s_waitcnt lgkmcnt(4)
    v_mfma_f32_16x16x32_bf16 v[176:179], v[76:79], v[48:51], v[176:179]
    v_mfma_f32_16x16x32_bf16 v[180:183], v[76:79], v[52:55], v[180:183]
    v_mfma_f32_16x16x32_bf16 v[184:187], v[76:79], v[56:59], v[184:187]
    v_mfma_f32_16x16x32_bf16 v[188:191], v[76:79], v[60:63], v[188:191]
    ds_read_b64_tr_b16 v[72:73], v16 offset:23648
    ds_read_b64_tr_b16 v[74:75], v16 offset:25440
    s_waitcnt lgkmcnt(4)
    v_mfma_f32_16x16x32_bf16 v[192:195], v[64:67], v[48:51], v[192:195]
    v_mfma_f32_16x16x32_bf16 v[196:199], v[64:67], v[52:55], v[196:199]
    v_mfma_f32_16x16x32_bf16 v[200:203], v[64:67], v[56:59], v[200:203]
    v_mfma_f32_16x16x32_bf16 v[204:207], v[64:67], v[60:63], v[204:207]
    ds_read_b64_tr_b16 v[76:77], v16 offset:23680
    ds_read_b64_tr_b16 v[78:79], v16 offset:25472
    s_waitcnt lgkmcnt(4)
    v_mfma_f32_16x16x32_bf16 v[208:211], v[68:71], v[48:51], v[208:211]
    v_mfma_f32_16x16x32_bf16 v[212:215], v[68:71], v[52:55], v[212:215]
    v_mfma_f32_16x16x32_bf16 v[216:219], v[68:71], v[56:59], v[216:219]
    v_mfma_f32_16x16x32_bf16 v[220:223], v[68:71], v[60:63], v[220:223]
    v_add_u32 v14, s38, v13
    v_add_u32 v16, s38, v15
    s_add_u32 s38, s38, 36864
    s_cmp_eq_u32 s38, 147456
    s_cselect_b32 s38, 0, s38
    ds_read_b128 v[32:35], v14 offset:0
    ds_read_b128 v[36:39], v14 offset:1024
    ds_read_b128 v[40:43], v14 offset:2048
    ds_read_b128 v[44:47], v14 offset:3072
    ds_read_b64_tr_b16 v[64:65], v16 offset:16384
    ds_read_b64_tr_b16 v[66:67], v16 offset:18176
    s_waitcnt lgkmcnt(8)
    v_mfma_f32_16x16x32_bf16 v[224:227], v[72:75], v[48:51], v[224:227]
    v_mfma_f32_16x16x32_bf16 v[228:231], v[72:75], v[52:55], v[228:231]
    v_mfma_f32_16x16x32_bf16 v[232:235], v[72:75], v[56:59], v[232:235]
    v_mfma_f32_16x16x32_bf16 v[236:239], v[72:75], v[60:63], v[236:239]
    ds_read_b64_tr_b16 v[68:69], v16 offset:16416
    ds_read_b64_tr_b16 v[70:71], v16 offset:18208
    s_waitcnt lgkmcnt(8)
    v_mfma_f32_16x16x32_bf16 v[240:243], v[76:79], v[48:51], v[240:243]
    v_mfma_f32_16x16x32_bf16 v[244:247], v[76:79], v[52:55], v[244:247]
    v_mfma_f32_16x16x32_bf16 v[248:251], v[76:79], v[56:59], v[248:251]
    v_mfma_f32_16x16x32_bf16 v[252:255], v[76:79], v[60:63], v[252:255]
    s_waitcnt vmcnt(5)
    s_barrier
    ds_read_b64_tr_b16 v[72:73], v16 offset:16448
    ds_read_b64_tr_b16 v[74:75], v16 offset:18240
    s_waitcnt lgkmcnt(4)
    v_mfma_f32_16x16x32_bf16 v[96:99], v[64:67], v[32:35], v[96:99]
    v_mfma_f32_16x16x32_bf16 v[100:103], v[64:67], v[36:39], v[100:103]
    v_mfma_f32_16x16x32_bf16 v[104:107], v[64:67], v[40:43], v[104:107]
    v_mfma_f32_16x16x32_bf16 v[108:111], v[64:67], v[44:47], v[108:111]
    ds_read_b64_tr_b16 v[76:77], v16 offset:16480
    ds_read_b64_tr_b16 v[78:79], v16 offset:18272
    s_waitcnt lgkmcnt(4)
    v_mfma_f32_16x16x32_bf16 v[112:115], v[68:71], v[32:35], v[112:115]
    v_mfma_f32_16x16x32_bf16 v[116:119], v[68:71], v[36:39], v[116:119]
    v_mfma_f32_16x16x32_bf16 v[120:123], v[68:71], v[40:43], v[120:123]
    v_mfma_f32_16x16x32_bf16 v[124:127], v[68:71], v[44:47], v[124:127]
    ds_read_b64_tr_b16 v[64:65], v16 offset:16512
    ds_read_b64_tr_b16 v[66:67], v16 offset:18304
    s_waitcnt lgkmcnt(4)
    v_mfma_f32_16x16x32_bf16 v[128:131], v[72:75], v[32:35], v[128:131]
    v_mfma_f32_16x16x32_bf16 v[132:135], v[72:75], v[36:39], v[132:135]
    v_mfma_f32_16x16x32_bf16 v[136:139], v[72:75], v[40:43], v[136:139]
    v_mfma_f32_16x16x32_bf16 v[140:143], v[72:75], v[44:47], v[140:143]
    ds_read_b64_tr_b16 v[68:69], v16 offset:23552
    ds_read_b64_tr_b16 v[70:71], v16 offset:25344
    s_waitcnt lgkmcnt(4)
    v_mfma_f32_16x16x32_bf16 v[144:147], v[76:79], v[32:35], v[144:147]
    v_mfma_f32_16x16x32_bf16 v[148:151], v[76:79], v[36:39], v[148:151]
    v_mfma_f32_16x16x32_bf16 v[152:155], v[76:79], v[40:43], v[152:155]
    v_mfma_f32_16x16x32_bf16 v[156:159], v[76:79], v[44:47], v[156:159]
    ds_read_b64_tr_b16 v[72:73], v16 offset:23584
    ds_read_b64_tr_b16 v[74:75], v16 offset:25376
    s_waitcnt lgkmcnt(4)
    v_mfma_f32_16x16x32_bf16 v[160:163], v[64:67], v[32:35], v[160:163]
    v_mfma_f32_16x16x32_bf16 v[164:167], v[64:67], v[36:39], v[164:167]
    v_mfma_f32_16x16x32_bf16 v[168:171], v[64:67], v[40:43], v[168:171]
    v_mfma_f32_16x16x32_bf16 v[172:175], v[64:67], v[44:47], v[172:175]
    ds_read_b64_tr_b16 v[76:77], v16 offset:23616
    ds_read_b64_tr_b16 v[78:79], v16 offset:25408
    s_waitcnt lgkmcnt(4)
    v_mfma_f32_16x16x32_bf16 v[176:179], v[68:71], v[32:35], v[176:179]
    v_mfma_f32_16x16x32_bf16 v[180:183], v[68:71], v[36:39], v[180:183]
    v_mfma_f32_16x16x32_bf16 v[184:187], v[68:71], v[40:43], v[184:187]
    v_mfma_f32_16x16x32_bf16 v[188:191], v[68:71], v[44:47], v[188:191]
    ds_read_b64_tr_b16 v[64:65], v16 offset:23648
    ds_read_b64_tr_b16 v[66:67], v16 offset:25440
    s_waitcnt lgkmcnt(4)
    v_mfma_f32_16x16x32_bf16 v[192:195], v[72:75], v[32:35], v[192:195]
    v_mfma_f32_16x16x32_bf16 v[196:199], v[72:75], v[36:39], v[196:199]
    v_mfma_f32_16x16x32_bf16 v[200:203], v[72:75], v[40:43], v[200:203]
    v_mfma_f32_16x16x32_bf16 v[204:207], v[72:75], v[44:47], v[204:207]
    ds_read_b64_tr_b16 v[68:69], v16 offset:23680
    ds_read_b64_tr_b16 v[70:71], v16 offset:25472
    s_waitcnt lgkmcnt(4)
    v_mfma_f32_16x16x32_bf16 v[208:211], v[76:79], v[32:35], v[208:211]
    v_mfma_f32_16x16x32_bf16 v[212:215], v[76:79], v[36:39], v[212:215]
    v_mfma_f32_16x16x32_bf16 v[216:219], v[76:79], v[40:43], v[216:219]
    v_mfma_f32_16x16x32_bf16 v[220:223], v[76:79], v[44:47], v[220:223]
    v_add_u32 v14, s38, v13
    v_add_u32 v16, s38, v15
    s_add_u32 s38, s38, 36864
    s_cmp_eq_u32 s38, 147456
    s_cselect_b32 s38, 0, s38
    ds_read_b128 v[48:51], v14 offset:0
    ds_read_b128 v[52:55], v14 offset:1024
    ds_read_b128 v[56:59], v14 offset:2048
    ds_read_b128 v[60:63], v14 offset:3072
    ds_read_b64_tr_b16 v[72:73], v16 offset:16384
    ds_read_b64_tr_b16 v[74:75], v16 offset:18176
    s_waitcnt lgkmcnt(8)
    v_mfma_f32_16x16x32_bf16 v[224:227], v[64:67], v[32:35], v[224:227]
    v_mfma_f32_16x16x32_bf16 v[228:231], v[64:67], v[36:39], v[228:231]
    v_mfma_f32_16x16x32_bf16 v[232:235], v[64:67], v[40:43], v[232:235]
    v_mfma_f32_16x16x32_bf16 v[236:239], v[64:67], v[44:47], v[236:239]
    ds_read_b64_tr_b16 v[76:77], v16 offset:16416
    ds_read_b64_tr_b16 v[78:79], v16 offset:18208
    s_waitcnt lgkmcnt(8)
    v_mfma_f32_16x16x32_bf16 v[240:243], v[68:71], v[32:35], v[240:243]
    v_mfma_f32_16x16x32_bf16 v[244:247], v[68:71], v[36:39], v[244:247]
    v_mfma_f32_16x16x32_bf16 v[248:251], v[68:71], v[40:43], v[248:251]
    v_mfma_f32_16x16x32_bf16 v[252:255], v[68:71], v[44:47], v[252:255]
    ds_read_b64_tr_b16 v[64:65], v16 offset:16448
    ds_read_b64_tr_b16 v[66:67], v16 offset:18240
    s_waitcnt lgkmcnt(4)
    v_mfma_f32_16x16x32_bf16 v[96:99], v[72:75], v[48:51], v[96:99]
    v_mfma_f32_16x16x32_bf16 v[100:103], v[72:75], v[52:55], v[100:103]
    v_mfma_f32_16x16x32_bf16 v[104:107], v[72:75], v[56:59], v[104:107]
    v_mfma_f32_16x16x32_bf16 v[108:111], v[72:75], v[60:63], v[108:111]
    ds_read_b64_tr_b16 v[68:69], v16 offset:16480
    ds_read_b64_tr_b16 v[70:71], v16 offset:18272
    s_waitcnt lgkmcnt(4)
    v_mfma_f32_16x16x32_bf16 v[112:115], v[76:79], v[48:51], v[112:115]
    v_mfma_f32_16x16x32_bf16 v[116:119], v[76:79], v[52:55], v[116:119]
    v_mfma_f32_16x16x32_bf16 v[120:123], v[76:79], v[56:59], v[120:123]
    v_mfma_f32_16x16x32_bf16 v[124:127], v[76:79], v[60:63], v[124:127]
    ds_read_b64_tr_b16 v[72:73], v16 offset:16512
    ds_read_b64_tr_b16 v[74:75], v16 offset:18304
    s_waitcnt lgkmcnt(4)
    v_mfma_f32_16x16x32_bf16 v[128:131], v[64:67], v[48:51], v[128:131]
    v_mfma_f32_16x16x32_bf16 v[132:135], v[64:67], v[52:55], v[132:135]
    v_mfma_f32_16x16x32_bf16 v[136:139], v[64:67], v[56:59], v[136:139]
    v_mfma_f32_16x16x32_bf16 v[140:143], v[64:67], v[60:63], v[140:143]
    ds_read_b64_tr_b16 v[76:77], v16 offset:23552
    ds_read_b64_tr_b16 v[78:79], v16 offset:25344
    s_waitcnt lgkmcnt(4)
    v_mfma_f32_16x16x32_bf16 v[144:147], v[68:71], v[48:51], v[144:147]
    v_mfma_f32_16x16x32_bf16 v[148:151], v[68:71], v[52:55], v[148:151]
    v_mfma_f32_16x16x32_bf16 v[152:155], v[68:71], v[56:59], v[152:155]
    v_mfma_f32_16x16x32_bf16 v[156:159], v[68:71], v[60:63], v[156:159]
    ds_read_b64_tr_b16 v[64:65], v16 offset:23584
    ds_read_b64_tr_b16 v[66:67], v16 offset:25376
    s_waitcnt lgkmcnt(4)
    v_mfma_f32_16x16x32_bf16 v[160:163], v[72:75], v[48:51], v[160:163]
    v_mfma_f32_16x16x32_bf16 v[164:167], v[72:75], v[52:55], v[164:167]
    v_mfma_f32_16x16x32_bf16 v[168:171], v[72:75], v[56:59], v[168:171]
    v_mfma_f32_16x16x32_bf16 v[172:175], v[72:75], v[60:63], v[172:175]
    ds_read_b64_tr_b16 v[68:69], v16 offset:23616
    ds_read_b64_tr_b16 v[70:71], v16 offset:25408
    s_waitcnt lgkmcnt(4)
    v_mfma_f32_16x16x32_bf16 v[176:179], v[76:79], v[48:51], v[176:179]
    v_mfma_f32_16x16x32_bf16 v[180:183], v[76:79], v[52:55], v[180:183]
    v_mfma_f32_16x16x32_bf16 v[184:187], v[76:79], v[56:59], v[184:187]
    v_mfma_f32_16x16x32_bf16 v[188:191], v[76:79], v[60:63], v[188:191]
    ds_read_b64_tr_b16 v[72:73], v16 offset:23648
    ds_read_b64_tr_b16 v[74:75], v16 offset:25440
    s_waitcnt lgkmcnt(4)
    v_mfma_f32_16x16x32_bf16 v[192:195], v[64:67], v[48:51], v[192:195]
    v_mfma_f32_16x16x32_bf16 v[196:199], v[64:67], v[52:55], v[196:199]
    v_mfma_f32_16x16x32_bf16 v[200:203], v[64:67], v[56:59], v[200:203]
    v_mfma_f32_16x16x32_bf16 v[204:207], v[64:67], v[60:63], v[204:207]
    ds_read_b64_tr_b16 v[76:77], v16 offset:23680
    ds_read_b64_tr_b16 v[78:79], v16 offset:25472
    s_waitcnt lgkmcnt(4)
    v_mfma_f32_16x16x32_bf16 v[208:211], v[68:71], v[48:51], v[208:211]
    v_mfma_f32_16x16x32_bf16 v[212:215], v[68:71], v[52:55], v[212:215]
    v_mfma_f32_16x16x32_bf16 v[216:219], v[68:71], v[56:59], v[216:219]
    v_mfma_f32_16x16x32_bf16 v[220:223], v[68:71], v[60:63], v[220:223]
    s_waitcnt lgkmcnt(2)
    v_mfma_f32_16x16x32_bf16 v[224:227], v[72:75], v[48:51], v[224:227]
    v_mfma_f32_16x16x32_bf16 v[228:231], v[72:75], v[52:55], v[228:231]
    v_mfma_f32_16x16x32_bf16 v[232:235], v[72:75], v[56:59], v[232:235]
    v_mfma_f32_16x16x32_bf16 v[236:239], v[72:75], v[60:63], v[236:239]
    s_waitcnt lgkmcnt(0)
    v_mfma_f32_16x16x32_bf16 v[240:243], v[76:79], v[48:51], v[240:243]
    v_mfma_f32_16x16x32_bf16 v[244:247], v[76:79], v[52:55], v[244:247]
    v_mfma_f32_16x16x32_bf16 v[248:251], v[76:79], v[56:59], v[248:251]
    v_mfma_f32_16x16x32_bf16 v[252:255], v[76:79], v[60:63], v[252:255]
    s_nop 7
    s_nop 7
    s_barrier
    s_mov_b32 s40, s20
    s_mov_b32 s41, s21
    s_mov_b32 s42, 256
    s_mov_b32 s43, 0x00020000
    s_mov_b32 s44, s18
    s_mov_b32 s45, s19
    s_mov_b32 s46, 2048
    s_mov_b32 s47, 0x00020000
    s_lshl_b32 s82, s30, 8
    s_lshl_b32 s83, s33, 6
    s_add_u32 s82, s82, s83
    s_mul_i32 s49, s82, 9216
    s_add_u32 s48, s49, s35
    s_add_u32 s48, s48, 2048
    v_mul_u32_u24 v21, 9216, v5
    v_lshlrev_b32 v22, 3, v2
    v_add_u32 v21, v21, v22
    v_mul_u32_u24 v19, 9216, v5
    v_and_b32 v22, 1, v2
    v_lshlrev_b32 v22, 5, v22
    v_add_u32 v19, v19, v22
    v_lshrrev_b32 v22, 1, v2
    v_lshlrev_b32 v22, 4, v22
    v_add_u32 v19, v19, v22
    s_lshl_b32 s82, s30, 8
    s_lshl_b32 s83, s31, 3
    s_add_u32 s82, s82, s83
    s_lshl_b32 s83, s33, 1
    s_add_u32 s82, s82, s83
    s_add_u32 s50, s82, 0
    s_lshl_b32 s82, s50, 11
    v_lshlrev_b32 v20, 5, v1
    buffer_load_dwordx4 v[56:59], v20, s[4:7], s82 offen
    buffer_load_dwordx4 v[60:63], v20, s[4:7], s82 offen offset:16
    buffer_load_dwordx4 v[88:91], v20, s[44:47], 0 offen
    buffer_load_dwordx4 v[92:95], v20, s[44:47], 0 offen offset:16
    s_lshl_b32 s82, s30, 8
    s_lshl_b32 s83, s31, 3
    s_add_u32 s82, s82, s83
    s_lshl_b32 s83, s33, 1
    s_add_u32 s82, s82, s83
    s_add_u32 s51, s82, 1
    s_lshl_b32 s82, s51, 11
    v_lshlrev_b32 v20, 5, v1
    buffer_load_dwordx4 v[72:75], v20, s[4:7], s82 offen
    buffer_load_dwordx4 v[76:79], v20, s[4:7], s82 offen offset:16
    s_add_u32 s56, s48, 0
    v_cvt_pk_bf16_f32 v24, v96, v97
    v_cvt_pk_bf16_f32 v25, v98, v99
    v_cvt_pk_bf16_f32 v26, v176, v177
    v_cvt_pk_bf16_f32 v27, v178, v179
    v_lshlrev_b32 v28, 16, v24
    v_lshlrev_b32 v29, 16, v26
    v_and_b32 v24, 0xffff0000, v24
    v_and_b32 v26, 0xffff0000, v26
    v_mul_f32 v28, v28, v29
    v_mul_f32 v24, v24, v26
    v_lshlrev_b32 v29, 16, v25
    v_lshlrev_b32 v26, 16, v27
    v_and_b32 v25, 0xffff0000, v25
    v_and_b32 v27, 0xffff0000, v27
    v_mul_f32 v29, v29, v26
    v_mul_f32 v25, v25, v27
    v_cvt_pk_bf16_f32 v32, v28, v24
    v_cvt_pk_bf16_f32 v33, v29, v25
    v_cvt_pk_bf16_f32 v24, v112, v113
    v_cvt_pk_bf16_f32 v25, v114, v115
    v_cvt_pk_bf16_f32 v26, v192, v193
    v_cvt_pk_bf16_f32 v27, v194, v195
    v_lshlrev_b32 v28, 16, v24
    v_lshlrev_b32 v29, 16, v26
    v_and_b32 v24, 0xffff0000, v24
    v_and_b32 v26, 0xffff0000, v26
    v_mul_f32 v28, v28, v29
    v_mul_f32 v24, v24, v26
    v_lshlrev_b32 v29, 16, v25
    v_lshlrev_b32 v26, 16, v27
    v_and_b32 v25, 0xffff0000, v25
    v_and_b32 v27, 0xffff0000, v27
    v_mul_f32 v29, v29, v26
    v_mul_f32 v25, v25, v27
    v_cvt_pk_bf16_f32 v34, v28, v24
    v_cvt_pk_bf16_f32 v35, v29, v25
    s_nop 1
    v_permlane16_swap_b32 v32, v34
    v_permlane16_swap_b32 v33, v35
    buffer_store_dwordx4 v[32:35], v19, s[8:11], s56 offen offset:0
    v_cvt_pk_bf16_f32 v24, v128, v129
    v_cvt_pk_bf16_f32 v25, v130, v131
    v_cvt_pk_bf16_f32 v26, v208, v209
    v_cvt_pk_bf16_f32 v27, v210, v211
    v_lshlrev_b32 v28, 16, v24
    v_lshlrev_b32 v29, 16, v26
    v_and_b32 v24, 0xffff0000, v24
    v_and_b32 v26, 0xffff0000, v26
    v_mul_f32 v28, v28, v29
    v_mul_f32 v24, v24, v26
    v_lshlrev_b32 v29, 16, v25
    v_lshlrev_b32 v26, 16, v27
    v_and_b32 v25, 0xffff0000, v25
    v_and_b32 v27, 0xffff0000, v27
    v_mul_f32 v29, v29, v26
    v_mul_f32 v25, v25, v27
    v_cvt_pk_bf16_f32 v36, v28, v24
    v_cvt_pk_bf16_f32 v37, v29, v25
    v_cvt_pk_bf16_f32 v24, v144, v145
    v_cvt_pk_bf16_f32 v25, v146, v147
    v_cvt_pk_bf16_f32 v26, v224, v225
    v_cvt_pk_bf16_f32 v27, v226, v227
    v_lshlrev_b32 v28, 16, v24
    v_lshlrev_b32 v29, 16, v26
    v_and_b32 v24, 0xffff0000, v24
    v_and_b32 v26, 0xffff0000, v26
    v_mul_f32 v28, v28, v29
    v_mul_f32 v24, v24, v26
    v_lshlrev_b32 v29, 16, v25
    v_lshlrev_b32 v26, 16, v27
    v_and_b32 v25, 0xffff0000, v25
    v_and_b32 v27, 0xffff0000, v27
    v_mul_f32 v29, v29, v26
    v_mul_f32 v25, v25, v27
    v_cvt_pk_bf16_f32 v38, v28, v24
    v_cvt_pk_bf16_f32 v39, v29, v25
    s_nop 1
    v_permlane16_swap_b32 v36, v38
    v_permlane16_swap_b32 v37, v39
    buffer_store_dwordx4 v[36:39], v19, s[8:11], s56 offen offset:64
    v_cvt_pk_bf16_f32 v24, v160, v161
    v_cvt_pk_bf16_f32 v25, v162, v163
    v_cvt_pk_bf16_f32 v26, v240, v241
    v_cvt_pk_bf16_f32 v27, v242, v243
    v_lshlrev_b32 v28, 16, v24
    v_lshlrev_b32 v29, 16, v26
    v_and_b32 v24, 0xffff0000, v24
    v_and_b32 v26, 0xffff0000, v26
    v_mul_f32 v28, v28, v29
    v_mul_f32 v24, v24, v26
    v_lshlrev_b32 v29, 16, v25
    v_lshlrev_b32 v26, 16, v27
    v_and_b32 v25, 0xffff0000, v25
    v_and_b32 v27, 0xffff0000, v27
    v_mul_f32 v29, v29, v26
    v_mul_f32 v25, v25, v27
    v_cvt_pk_bf16_f32 v40, v28, v24
    v_cvt_pk_bf16_f32 v41, v29, v25
    buffer_store_dwordx2 v[40:41], v21, s[8:11], s56 offen offset:128
    s_barrier
    s_add_u32 s56, s48, 147456
    v_cvt_pk_bf16_f32 v24, v100, v101
    v_cvt_pk_bf16_f32 v25, v102, v103
    v_cvt_pk_bf16_f32 v26, v180, v181
    v_cvt_pk_bf16_f32 v27, v182, v183
    v_lshlrev_b32 v28, 16, v24
    v_lshlrev_b32 v29, 16, v26
    v_and_b32 v24, 0xffff0000, v24
    v_and_b32 v26, 0xffff0000, v26
    v_mul_f32 v28, v28, v29
    v_mul_f32 v24, v24, v26
    v_lshlrev_b32 v29, 16, v25
    v_lshlrev_b32 v26, 16, v27
    v_and_b32 v25, 0xffff0000, v25
    v_and_b32 v27, 0xffff0000, v27
    v_mul_f32 v29, v29, v26
    v_mul_f32 v25, v25, v27
    v_cvt_pk_bf16_f32 v44, v28, v24
    v_cvt_pk_bf16_f32 v45, v29, v25
    v_cvt_pk_bf16_f32 v24, v116, v117
    v_cvt_pk_bf16_f32 v25, v118, v119
    v_cvt_pk_bf16_f32 v26, v196, v197
    v_cvt_pk_bf16_f32 v27, v198, v199
    v_lshlrev_b32 v28, 16, v24
    v_lshlrev_b32 v29, 16, v26
    v_and_b32 v24, 0xffff0000, v24
    v_and_b32 v26, 0xffff0000, v26
    v_mul_f32 v28, v28, v29
    v_mul_f32 v24, v24, v26
    v_lshlrev_b32 v29, 16, v25
    v_lshlrev_b32 v26, 16, v27
    v_and_b32 v25, 0xffff0000, v25
    v_and_b32 v27, 0xffff0000, v27
    v_mul_f32 v29, v29, v26
    v_mul_f32 v25, v25, v27
    v_cvt_pk_bf16_f32 v46, v28, v24
    v_cvt_pk_bf16_f32 v47, v29, v25
    s_nop 1
    v_permlane16_swap_b32 v44, v46
    v_permlane16_swap_b32 v45, v47
    buffer_store_dwordx4 v[44:47], v19, s[8:11], s56 offen offset:0
    v_cvt_pk_bf16_f32 v24, v132, v133
    v_cvt_pk_bf16_f32 v25, v134, v135
    v_cvt_pk_bf16_f32 v26, v212, v213
    v_cvt_pk_bf16_f32 v27, v214, v215
    v_lshlrev_b32 v28, 16, v24
    v_lshlrev_b32 v29, 16, v26
    v_and_b32 v24, 0xffff0000, v24
    v_and_b32 v26, 0xffff0000, v26
    v_mul_f32 v28, v28, v29
    v_mul_f32 v24, v24, v26
    v_lshlrev_b32 v29, 16, v25
    v_lshlrev_b32 v26, 16, v27
    v_and_b32 v25, 0xffff0000, v25
    v_and_b32 v27, 0xffff0000, v27
    v_mul_f32 v29, v29, v26
    v_mul_f32 v25, v25, v27
    v_cvt_pk_bf16_f32 v32, v28, v24
    v_cvt_pk_bf16_f32 v33, v29, v25
    v_cvt_pk_bf16_f32 v24, v148, v149
    v_cvt_pk_bf16_f32 v25, v150, v151
    v_cvt_pk_bf16_f32 v26, v228, v229
    v_cvt_pk_bf16_f32 v27, v230, v231
    v_lshlrev_b32 v28, 16, v24
    v_lshlrev_b32 v29, 16, v26
    v_and_b32 v24, 0xffff0000, v24
    v_and_b32 v26, 0xffff0000, v26
    v_mul_f32 v28, v28, v29
    v_mul_f32 v24, v24, v26
    v_lshlrev_b32 v29, 16, v25
    v_lshlrev_b32 v26, 16, v27
    v_and_b32 v25, 0xffff0000, v25
    v_and_b32 v27, 0xffff0000, v27
    v_mul_f32 v29, v29, v26
    v_mul_f32 v25, v25, v27
    v_cvt_pk_bf16_f32 v34, v28, v24
    v_cvt_pk_bf16_f32 v35, v29, v25
    s_nop 1
    v_permlane16_swap_b32 v32, v34
    v_permlane16_swap_b32 v33, v35
    buffer_store_dwordx4 v[32:35], v19, s[8:11], s56 offen offset:64
    v_cvt_pk_bf16_f32 v24, v164, v165
    v_cvt_pk_bf16_f32 v25, v166, v167
    v_cvt_pk_bf16_f32 v26, v244, v245
    v_cvt_pk_bf16_f32 v27, v246, v247
    v_lshlrev_b32 v28, 16, v24
    v_lshlrev_b32 v29, 16, v26
    v_and_b32 v24, 0xffff0000, v24
    v_and_b32 v26, 0xffff0000, v26
    v_mul_f32 v28, v28, v29
    v_mul_f32 v24, v24, v26
    v_lshlrev_b32 v29, 16, v25
    v_lshlrev_b32 v26, 16, v27
    v_and_b32 v25, 0xffff0000, v25
    v_and_b32 v27, 0xffff0000, v27
    v_mul_f32 v29, v29, v26
    v_mul_f32 v25, v25, v27
    v_cvt_pk_bf16_f32 v36, v28, v24
    v_cvt_pk_bf16_f32 v37, v29, v25
    buffer_store_dwordx2 v[36:37], v21, s[8:11], s56 offen offset:128
    s_barrier
    s_add_u32 s56, s48, 294912
    v_cvt_pk_bf16_f32 v24, v104, v105
    v_cvt_pk_bf16_f32 v25, v106, v107
    v_cvt_pk_bf16_f32 v26, v184, v185
    v_cvt_pk_bf16_f32 v27, v186, v187
    v_lshlrev_b32 v28, 16, v24
    v_lshlrev_b32 v29, 16, v26
    v_and_b32 v24, 0xffff0000, v24
    v_and_b32 v26, 0xffff0000, v26
    v_mul_f32 v28, v28, v29
    v_mul_f32 v24, v24, v26
    v_lshlrev_b32 v29, 16, v25
    v_lshlrev_b32 v26, 16, v27
    v_and_b32 v25, 0xffff0000, v25
    v_and_b32 v27, 0xffff0000, v27
    v_mul_f32 v29, v29, v26
    v_mul_f32 v25, v25, v27
    v_cvt_pk_bf16_f32 v40, v28, v24
    v_cvt_pk_bf16_f32 v41, v29, v25
    v_cvt_pk_bf16_f32 v24, v120, v121
    v_cvt_pk_bf16_f32 v25, v122, v123
    v_cvt_pk_bf16_f32 v26, v200, v201
    v_cvt_pk_bf16_f32 v27, v202, v203
    v_lshlrev_b32 v28, 16, v24
    v_lshlrev_b32 v29, 16, v26
    v_and_b32 v24, 0xffff0000, v24
    v_and_b32 v26, 0xffff0000, v26
    v_mul_f32 v28, v28, v29
    v_mul_f32 v24, v24, v26
    v_lshlrev_b32 v29, 16, v25
    v_lshlrev_b32 v26, 16, v27
    v_and_b32 v25, 0xffff0000, v25
    v_and_b32 v27, 0xffff0000, v27
    v_mul_f32 v29, v29, v26
    v_mul_f32 v25, v25, v27
    v_cvt_pk_bf16_f32 v42, v28, v24
    v_cvt_pk_bf16_f32 v43, v29, v25
    s_nop 1
    v_permlane16_swap_b32 v40, v42
    v_permlane16_swap_b32 v41, v43
    buffer_store_dwordx4 v[40:43], v19, s[8:11], s56 offen offset:0
    v_cvt_pk_bf16_f32 v24, v136, v137
    v_cvt_pk_bf16_f32 v25, v138, v139
    v_cvt_pk_bf16_f32 v26, v216, v217
    v_cvt_pk_bf16_f32 v27, v218, v219
    v_lshlrev_b32 v28, 16, v24
    v_lshlrev_b32 v29, 16, v26
    v_and_b32 v24, 0xffff0000, v24
    v_and_b32 v26, 0xffff0000, v26
    v_mul_f32 v28, v28, v29
    v_mul_f32 v24, v24, v26
    v_lshlrev_b32 v29, 16, v25
    v_lshlrev_b32 v26, 16, v27
    v_and_b32 v25, 0xffff0000, v25
    v_and_b32 v27, 0xffff0000, v27
    v_mul_f32 v29, v29, v26
    v_mul_f32 v25, v25, v27
    v_cvt_pk_bf16_f32 v44, v28, v24
    v_cvt_pk_bf16_f32 v45, v29, v25
    v_cvt_pk_bf16_f32 v24, v152, v153
    v_cvt_pk_bf16_f32 v25, v154, v155
    v_cvt_pk_bf16_f32 v26, v232, v233
    v_cvt_pk_bf16_f32 v27, v234, v235
    v_lshlrev_b32 v28, 16, v24
    v_lshlrev_b32 v29, 16, v26
    v_and_b32 v24, 0xffff0000, v24
    v_and_b32 v26, 0xffff0000, v26
    v_mul_f32 v28, v28, v29
    v_mul_f32 v24, v24, v26
    v_lshlrev_b32 v29, 16, v25
    v_lshlrev_b32 v26, 16, v27
    v_and_b32 v25, 0xffff0000, v25
    v_and_b32 v27, 0xffff0000, v27
    v_mul_f32 v29, v29, v26
    v_mul_f32 v25, v25, v27
    v_cvt_pk_bf16_f32 v46, v28, v24
    v_cvt_pk_bf16_f32 v47, v29, v25
    s_nop 1
    v_permlane16_swap_b32 v44, v46
    v_permlane16_swap_b32 v45, v47
    buffer_store_dwordx4 v[44:47], v19, s[8:11], s56 offen offset:64
    v_cvt_pk_bf16_f32 v24, v168, v169
    v_cvt_pk_bf16_f32 v25, v170, v171
    v_cvt_pk_bf16_f32 v26, v248, v249
    v_cvt_pk_bf16_f32 v27, v250, v251
    v_lshlrev_b32 v28, 16, v24
    v_lshlrev_b32 v29, 16, v26
    v_and_b32 v24, 0xffff0000, v24
    v_and_b32 v26, 0xffff0000, v26
    v_mul_f32 v28, v28, v29
    v_mul_f32 v24, v24, v26
    v_lshlrev_b32 v29, 16, v25
    v_lshlrev_b32 v26, 16, v27
    v_and_b32 v25, 0xffff0000, v25
    v_and_b32 v27, 0xffff0000, v27
    v_mul_f32 v29, v29, v26
    v_mul_f32 v25, v25, v27
    v_cvt_pk_bf16_f32 v32, v28, v24
    v_cvt_pk_bf16_f32 v33, v29, v25
    buffer_store_dwordx2 v[32:33], v21, s[8:11], s56 offen offset:128
    s_add_u32 s56, s48, 442368
    v_cvt_pk_bf16_f32 v24, v108, v109
    v_cvt_pk_bf16_f32 v25, v110, v111
    v_cvt_pk_bf16_f32 v26, v188, v189
    v_cvt_pk_bf16_f32 v27, v190, v191
    v_lshlrev_b32 v28, 16, v24
    v_lshlrev_b32 v29, 16, v26
    v_and_b32 v24, 0xffff0000, v24
    v_and_b32 v26, 0xffff0000, v26
    v_mul_f32 v28, v28, v29
    v_mul_f32 v24, v24, v26
    v_lshlrev_b32 v29, 16, v25
    v_lshlrev_b32 v26, 16, v27
    v_and_b32 v25, 0xffff0000, v25
    v_and_b32 v27, 0xffff0000, v27
    v_mul_f32 v29, v29, v26
    v_mul_f32 v25, v25, v27
    v_cvt_pk_bf16_f32 v36, v28, v24
    v_cvt_pk_bf16_f32 v37, v29, v25
    v_cvt_pk_bf16_f32 v24, v124, v125
    v_cvt_pk_bf16_f32 v25, v126, v127
    v_cvt_pk_bf16_f32 v26, v204, v205
    v_cvt_pk_bf16_f32 v27, v206, v207
    v_lshlrev_b32 v28, 16, v24
    v_lshlrev_b32 v29, 16, v26
    v_and_b32 v24, 0xffff0000, v24
    v_and_b32 v26, 0xffff0000, v26
    v_mul_f32 v28, v28, v29
    v_mul_f32 v24, v24, v26
    v_lshlrev_b32 v29, 16, v25
    v_lshlrev_b32 v26, 16, v27
    v_and_b32 v25, 0xffff0000, v25
    v_and_b32 v27, 0xffff0000, v27
    v_mul_f32 v29, v29, v26
    v_mul_f32 v25, v25, v27
    v_cvt_pk_bf16_f32 v38, v28, v24
    v_cvt_pk_bf16_f32 v39, v29, v25
    s_nop 1
    v_permlane16_swap_b32 v36, v38
    v_permlane16_swap_b32 v37, v39
    buffer_store_dwordx4 v[36:39], v19, s[8:11], s56 offen offset:0
    v_cvt_pk_bf16_f32 v24, v140, v141
    v_cvt_pk_bf16_f32 v25, v142, v143
    v_cvt_pk_bf16_f32 v26, v220, v221
    v_cvt_pk_bf16_f32 v27, v222, v223
    v_lshlrev_b32 v28, 16, v24
    v_lshlrev_b32 v29, 16, v26
    v_and_b32 v24, 0xffff0000, v24
    v_and_b32 v26, 0xffff0000, v26
    v_mul_f32 v28, v28, v29
    v_mul_f32 v24, v24, v26
    v_lshlrev_b32 v29, 16, v25
    v_lshlrev_b32 v26, 16, v27
    v_and_b32 v25, 0xffff0000, v25
    v_and_b32 v27, 0xffff0000, v27
    v_mul_f32 v29, v29, v26
    v_mul_f32 v25, v25, v27
    v_cvt_pk_bf16_f32 v40, v28, v24
    v_cvt_pk_bf16_f32 v41, v29, v25
    v_cvt_pk_bf16_f32 v24, v156, v157
    v_cvt_pk_bf16_f32 v25, v158, v159
    v_cvt_pk_bf16_f32 v26, v236, v237
    v_cvt_pk_bf16_f32 v27, v238, v239
    v_lshlrev_b32 v28, 16, v24
    v_lshlrev_b32 v29, 16, v26
    v_and_b32 v24, 0xffff0000, v24
    v_and_b32 v26, 0xffff0000, v26
    v_mul_f32 v28, v28, v29
    v_mul_f32 v24, v24, v26
    v_lshlrev_b32 v29, 16, v25
    v_lshlrev_b32 v26, 16, v27
    v_and_b32 v25, 0xffff0000, v25
    v_and_b32 v27, 0xffff0000, v27
    v_mul_f32 v29, v29, v26
    v_mul_f32 v25, v25, v27
    v_cvt_pk_bf16_f32 v42, v28, v24
    v_cvt_pk_bf16_f32 v43, v29, v25
    s_nop 1
    v_permlane16_swap_b32 v40, v42
    v_permlane16_swap_b32 v41, v43
    buffer_store_dwordx4 v[40:43], v19, s[8:11], s56 offen offset:64
    v_cvt_pk_bf16_f32 v24, v172, v173
    v_cvt_pk_bf16_f32 v25, v174, v175
    v_cvt_pk_bf16_f32 v26, v252, v253
    v_cvt_pk_bf16_f32 v27, v254, v255
    v_lshlrev_b32 v28, 16, v24
    v_lshlrev_b32 v29, 16, v26
    v_and_b32 v24, 0xffff0000, v24
    v_and_b32 v26, 0xffff0000, v26
    v_mul_f32 v28, v28, v29
    v_mul_f32 v24, v24, v26
    v_lshlrev_b32 v29, 16, v25
    v_lshlrev_b32 v26, 16, v27
    v_and_b32 v25, 0xffff0000, v25
    v_and_b32 v27, 0xffff0000, v27
    v_mul_f32 v29, v29, v26
    v_mul_f32 v25, v25, v27
    v_cvt_pk_bf16_f32 v44, v28, v24
    v_cvt_pk_bf16_f32 v45, v29, v25
    buffer_store_dwordx2 v[44:45], v21, s[8:11], s56 offen offset:128
    s_waitcnt vmcnt(12)
    v_mov_b32 v24, 0
    v_lshlrev_b32 v25, 16, v56
    v_and_b32 v26, 0xffff0000, v56
    v_lshlrev_b32 v27, 16, v88
    v_and_b32 v28, 0xffff0000, v88
    v_mul_f32 v25, v25, v27
    v_mul_f32 v26, v26, v28
    v_cvt_pk_bf16_f32 v25, v25, v26
    v_lshlrev_b32 v26, 16, v25
    v_and_b32 v25, 0xffff0000, v25
    v_add_f32 v24, v24, v26
    v_add_f32 v24, v24, v25
    v_lshlrev_b32 v25, 16, v57
    v_and_b32 v26, 0xffff0000, v57
    v_lshlrev_b32 v27, 16, v89
    v_and_b32 v28, 0xffff0000, v89
    v_mul_f32 v25, v25, v27
    v_mul_f32 v26, v26, v28
    v_cvt_pk_bf16_f32 v25, v25, v26
    v_lshlrev_b32 v26, 16, v25
    v_and_b32 v25, 0xffff0000, v25
    v_add_f32 v24, v24, v26
    v_add_f32 v24, v24, v25
    v_lshlrev_b32 v25, 16, v58
    v_and_b32 v26, 0xffff0000, v58
    v_lshlrev_b32 v27, 16, v90
    v_and_b32 v28, 0xffff0000, v90
    v_mul_f32 v25, v25, v27
    v_mul_f32 v26, v26, v28
    v_cvt_pk_bf16_f32 v25, v25, v26
    v_lshlrev_b32 v26, 16, v25
    v_and_b32 v25, 0xffff0000, v25
    v_add_f32 v24, v24, v26
    v_add_f32 v24, v24, v25
    v_lshlrev_b32 v25, 16, v59
    v_and_b32 v26, 0xffff0000, v59
    v_lshlrev_b32 v27, 16, v91
    v_and_b32 v28, 0xffff0000, v91
    v_mul_f32 v25, v25, v27
    v_mul_f32 v26, v26, v28
    v_cvt_pk_bf16_f32 v25, v25, v26
    v_lshlrev_b32 v26, 16, v25
    v_and_b32 v25, 0xffff0000, v25
    v_add_f32 v24, v24, v26
    v_add_f32 v24, v24, v25
    v_lshlrev_b32 v25, 16, v60
    v_and_b32 v26, 0xffff0000, v60
    v_lshlrev_b32 v27, 16, v92
    v_and_b32 v28, 0xffff0000, v92
    v_mul_f32 v25, v25, v27
    v_mul_f32 v26, v26, v28
    v_cvt_pk_bf16_f32 v25, v25, v26
    v_lshlrev_b32 v26, 16, v25
    v_and_b32 v25, 0xffff0000, v25
    v_add_f32 v24, v24, v26
    v_add_f32 v24, v24, v25
    v_lshlrev_b32 v25, 16, v61
    v_and_b32 v26, 0xffff0000, v61
    v_lshlrev_b32 v27, 16, v93
    v_and_b32 v28, 0xffff0000, v93
    v_mul_f32 v25, v25, v27
    v_mul_f32 v26, v26, v28
    v_cvt_pk_bf16_f32 v25, v25, v26
    v_lshlrev_b32 v26, 16, v25
    v_and_b32 v25, 0xffff0000, v25
    v_add_f32 v24, v24, v26
    v_add_f32 v24, v24, v25
    v_lshlrev_b32 v25, 16, v62
    v_and_b32 v26, 0xffff0000, v62
    v_lshlrev_b32 v27, 16, v94
    v_and_b32 v28, 0xffff0000, v94
    v_mul_f32 v25, v25, v27
    v_mul_f32 v26, v26, v28
    v_cvt_pk_bf16_f32 v25, v25, v26
    v_lshlrev_b32 v26, 16, v25
    v_and_b32 v25, 0xffff0000, v25
    v_add_f32 v24, v24, v26
    v_add_f32 v24, v24, v25
    v_lshlrev_b32 v25, 16, v63
    v_and_b32 v26, 0xffff0000, v63
    v_lshlrev_b32 v27, 16, v95
    v_and_b32 v28, 0xffff0000, v95
    v_mul_f32 v25, v25, v27
    v_mul_f32 v26, v26, v28
    v_cvt_pk_bf16_f32 v25, v25, v26
    v_lshlrev_b32 v26, 16, v25
    v_and_b32 v25, 0xffff0000, v25
    v_add_f32 v24, v24, v26
    v_add_f32 v24, v24, v25
    ds_swizzle_b32 v25, v24 offset:1055
    s_waitcnt lgkmcnt(0)
    v_add_f32 v24, v24, v25
    ds_swizzle_b32 v25, v24 offset:2079
    s_waitcnt lgkmcnt(0)
    v_add_f32 v24, v24, v25
    ds_swizzle_b32 v25, v24 offset:4127
    s_waitcnt lgkmcnt(0)
    v_add_f32 v24, v24, v25
    ds_swizzle_b32 v25, v24 offset:8223
    s_waitcnt lgkmcnt(0)
    v_add_f32 v24, v24, v25
    ds_swizzle_b32 v25, v24 offset:16415
    s_waitcnt lgkmcnt(0)
    v_add_f32 v24, v24, v25
    s_nop 0
    v_readlane_b32 s82, v24, 32
    s_nop 1
    v_add_f32 v24, s82, v24
    v_cvt_pk_bf16_f32 v24, v24, v24
    v_lshlrev_b32 v24, 16, v24
    v_mul_f32 v24, 0xbfb8aa3b, v24
    v_exp_f32 v24, v24
    s_nop 0
    v_add_f32 v24, 1.0, v24
    v_rcp_f32 v24, v24
    s_nop 0
    v_cvt_pk_bf16_f32 v24, v24, v24
    v_lshlrev_b32 v24, 16, v24
    s_lshl_b32 s82, s50, 2
    s_add_u32 s82, s82, 20447232
    v_mov_b32 v25, 0
    s_mov_b64 s[54:55], exec
    s_mov_b64 exec, 1
    buffer_store_dword v24, v25, s[8:11], s82 offen
    s_mov_b64 exec, s[54:55]
    v_mov_b32 v24, 0
    v_lshlrev_b32 v25, 16, v72
    v_and_b32 v26, 0xffff0000, v72
    v_lshlrev_b32 v27, 16, v88
    v_and_b32 v28, 0xffff0000, v88
    v_mul_f32 v25, v25, v27
    v_mul_f32 v26, v26, v28
    v_cvt_pk_bf16_f32 v25, v25, v26
    v_lshlrev_b32 v26, 16, v25
    v_and_b32 v25, 0xffff0000, v25
    v_add_f32 v24, v24, v26
    v_add_f32 v24, v24, v25
    v_lshlrev_b32 v25, 16, v73
    v_and_b32 v26, 0xffff0000, v73
    v_lshlrev_b32 v27, 16, v89
    v_and_b32 v28, 0xffff0000, v89
    v_mul_f32 v25, v25, v27
    v_mul_f32 v26, v26, v28
    v_cvt_pk_bf16_f32 v25, v25, v26
    v_lshlrev_b32 v26, 16, v25
    v_and_b32 v25, 0xffff0000, v25
    v_add_f32 v24, v24, v26
    v_add_f32 v24, v24, v25
    v_lshlrev_b32 v25, 16, v74
    v_and_b32 v26, 0xffff0000, v74
    v_lshlrev_b32 v27, 16, v90
    v_and_b32 v28, 0xffff0000, v90
    v_mul_f32 v25, v25, v27
    v_mul_f32 v26, v26, v28
    v_cvt_pk_bf16_f32 v25, v25, v26
    v_lshlrev_b32 v26, 16, v25
    v_and_b32 v25, 0xffff0000, v25
    v_add_f32 v24, v24, v26
    v_add_f32 v24, v24, v25
    v_lshlrev_b32 v25, 16, v75
    v_and_b32 v26, 0xffff0000, v75
    v_lshlrev_b32 v27, 16, v91
    v_and_b32 v28, 0xffff0000, v91
    v_mul_f32 v25, v25, v27
    v_mul_f32 v26, v26, v28
    v_cvt_pk_bf16_f32 v25, v25, v26
    v_lshlrev_b32 v26, 16, v25
    v_and_b32 v25, 0xffff0000, v25
    v_add_f32 v24, v24, v26
    v_add_f32 v24, v24, v25
    v_lshlrev_b32 v25, 16, v76
    v_and_b32 v26, 0xffff0000, v76
    v_lshlrev_b32 v27, 16, v92
    v_and_b32 v28, 0xffff0000, v92
    v_mul_f32 v25, v25, v27
    v_mul_f32 v26, v26, v28
    v_cvt_pk_bf16_f32 v25, v25, v26
    v_lshlrev_b32 v26, 16, v25
    v_and_b32 v25, 0xffff0000, v25
    v_add_f32 v24, v24, v26
    v_add_f32 v24, v24, v25
    v_lshlrev_b32 v25, 16, v77
    v_and_b32 v26, 0xffff0000, v77
    v_lshlrev_b32 v27, 16, v93
    v_and_b32 v28, 0xffff0000, v93
    v_mul_f32 v25, v25, v27
    v_mul_f32 v26, v26, v28
    v_cvt_pk_bf16_f32 v25, v25, v26
    v_lshlrev_b32 v26, 16, v25
    v_and_b32 v25, 0xffff0000, v25
    v_add_f32 v24, v24, v26
    v_add_f32 v24, v24, v25
    v_lshlrev_b32 v25, 16, v78
    v_and_b32 v26, 0xffff0000, v78
    v_lshlrev_b32 v27, 16, v94
    v_and_b32 v28, 0xffff0000, v94
    v_mul_f32 v25, v25, v27
    v_mul_f32 v26, v26, v28
    v_cvt_pk_bf16_f32 v25, v25, v26
    v_lshlrev_b32 v26, 16, v25
    v_and_b32 v25, 0xffff0000, v25
    v_add_f32 v24, v24, v26
    v_add_f32 v24, v24, v25
    v_lshlrev_b32 v25, 16, v79
    v_and_b32 v26, 0xffff0000, v79
    v_lshlrev_b32 v27, 16, v95
    v_and_b32 v28, 0xffff0000, v95
    v_mul_f32 v25, v25, v27
    v_mul_f32 v26, v26, v28
    v_cvt_pk_bf16_f32 v25, v25, v26
    v_lshlrev_b32 v26, 16, v25
    v_and_b32 v25, 0xffff0000, v25
    v_add_f32 v24, v24, v26
    v_add_f32 v24, v24, v25
    ds_swizzle_b32 v25, v24 offset:1055
    s_waitcnt lgkmcnt(0)
    v_add_f32 v24, v24, v25
    ds_swizzle_b32 v25, v24 offset:2079
    s_waitcnt lgkmcnt(0)
    v_add_f32 v24, v24, v25
    ds_swizzle_b32 v25, v24 offset:4127
    s_waitcnt lgkmcnt(0)
    v_add_f32 v24, v24, v25
    ds_swizzle_b32 v25, v24 offset:8223
    s_waitcnt lgkmcnt(0)
    v_add_f32 v24, v24, v25
    ds_swizzle_b32 v25, v24 offset:16415
    s_waitcnt lgkmcnt(0)
    v_add_f32 v24, v24, v25
    s_nop 0
    v_readlane_b32 s82, v24, 32
    s_nop 1
    v_add_f32 v24, s82, v24
    v_cvt_pk_bf16_f32 v24, v24, v24
    v_lshlrev_b32 v24, 16, v24
    v_mul_f32 v24, 0xbfb8aa3b, v24
    v_exp_f32 v24, v24
    s_nop 0
    v_add_f32 v24, 1.0, v24
    v_rcp_f32 v24, v24
    s_nop 0
    v_cvt_pk_bf16_f32 v24, v24, v24
    v_lshlrev_b32 v24, 16, v24
    s_lshl_b32 s82, s51, 2
    s_add_u32 s82, s82, 20447232
    v_mov_b32 v25, 0
    s_mov_b64 s[54:55], exec
    s_mov_b64 exec, 1
    buffer_store_dword v24, v25, s[8:11], s82 offen
    s_mov_b64 exec, s[54:55]
    s_barrier
    s_waitcnt vmcnt(0)
    s_branch k1_kernel_done
k1_kernel_wn1:
    v_add_u32 v14, s38, v13
    v_add_u32 v16, s38, v15
    v_add_u32 v18, s38, v17
    v_add_u32 v20, s38, v19
    s_add_u32 s38, s38, 36864
    s_cmp_eq_u32 s38, 147456
    s_cselect_b32 s38, 0, s38
    ds_read_b128 v[32:35], v14 offset:0
    ds_read_b128 v[36:39], v14 offset:1024
    ds_read_b128 v[40:43], v14 offset:2048
    ds_read_b128 v[44:47], v14 offset:3072
    ds_read_b64_tr_b16 v[64:65], v16 offset:16544
    ds_read_b64_tr_b16 v[66:67], v16 offset:18336
    ds_read_b64_tr_b16 v[68:69], v16 offset:16576
    ds_read_b64_tr_b16 v[70:71], v16 offset:18368
    s_mov_b32 s39, 14
k1_kernel_loop1:
    s_waitcnt vmcnt(6)
    s_barrier
    ds_read_b64_tr_b16 v[72:73], v16 offset:23712
    ds_read_b64_tr_b16 v[74:75], v16 offset:25504
    s_waitcnt lgkmcnt(4)
    v_mfma_f32_16x16x32_bf16 v[96:99], v[64:67], v[32:35], v[96:99]
    v_mfma_f32_16x16x32_bf16 v[100:103], v[64:67], v[36:39], v[100:103]
    v_mfma_f32_16x16x32_bf16 v[104:107], v[64:67], v[40:43], v[104:107]
    v_mfma_f32_16x16x32_bf16 v[108:111], v[64:67], v[44:47], v[108:111]
    s_add_u32 m0, s37, s76
    s_nop 0
    buffer_load_dwordx4 v6, s[40:43], s64 offen lds
    s_add_u32 s64, s64, s70
    ds_read_b64_tr_b16 v[76:77], v16 offset:23744
    ds_read_b64_tr_b16 v[78:79], v16 offset:25536
    s_waitcnt lgkmcnt(4)
    v_mfma_f32_16x16x32_bf16 v[112:115], v[68:71], v[32:35], v[112:115]
    v_mfma_f32_16x16x32_bf16 v[116:119], v[68:71], v[36:39], v[116:119]
    v_mfma_f32_16x16x32_bf16 v[120:123], v[68:71], v[40:43], v[120:123]
    v_mfma_f32_16x16x32_bf16 v[124:127], v[68:71], v[44:47], v[124:127]
    s_add_u32 m0, s37, s77
    s_nop 0
    buffer_load_dwordx4 v7, s[44:47], s65 offen lds
    s_add_u32 s65, s65, s71
    ds_read_b64_tr_b16 v[64:65], v18 offset:30720
    ds_read_b64_tr_b16 v[66:67], v18 offset:31488
    s_waitcnt lgkmcnt(4)
    v_mfma_f32_16x16x32_bf16 v[128:131], v[72:75], v[32:35], v[128:131]
    v_mfma_f32_16x16x32_bf16 v[132:135], v[72:75], v[36:39], v[132:135]
    v_mfma_f32_16x16x32_bf16 v[136:139], v[72:75], v[40:43], v[136:139]
    v_mfma_f32_16x16x32_bf16 v[140:143], v[72:75], v[44:47], v[140:143]
    s_add_u32 m0, s37, s78
    s_nop 0
    buffer_load_dwordx4 v8, s[48:51], s66 offen lds
    s_add_u32 s66, s66, s72
    ds_read_b64_tr_b16 v[68:69], v20 offset:30752
    ds_read_b64_tr_b16 v[70:71], v20 offset:31520
    s_waitcnt lgkmcnt(4)
    v_mfma_f32_16x16x32_bf16 v[144:147], v[76:79], v[32:35], v[144:147]
    v_mfma_f32_16x16x32_bf16 v[148:151], v[76:79], v[36:39], v[148:151]
    v_mfma_f32_16x16x32_bf16 v[152:155], v[76:79], v[40:43], v[152:155]
    v_mfma_f32_16x16x32_bf16 v[156:159], v[76:79], v[44:47], v[156:159]
    s_add_u32 m0, s37, s79
    s_nop 0
    buffer_load_dwordx4 v9, s[52:55], s67 offen lds
    s_add_u32 s67, s67, s73
    ds_read_b64_tr_b16 v[72:73], v18 offset:30784
    ds_read_b64_tr_b16 v[74:75], v18 offset:31552
    s_waitcnt lgkmcnt(4)
    v_mfma_f32_16x16x32_bf16 v[160:163], v[64:67], v[32:35], v[160:163]
    v_mfma_f32_16x16x32_bf16 v[164:167], v[64:67], v[36:39], v[164:167]
    v_mfma_f32_16x16x32_bf16 v[168:171], v[64:67], v[40:43], v[168:171]
    v_mfma_f32_16x16x32_bf16 v[172:175], v[64:67], v[44:47], v[172:175]
    s_add_u32 s37, s37, 36864
    s_cmp_eq_u32 s37, 147456
    s_cselect_b32 s37, 0, s37
    s_mov_b64 exec, 15
    global_load_dword v85, v[82:83], off
    s_cmp_lt_u32 s39, 2
    s_cbranch_scc1 nt_16
    v_add_co_u32 v82, vcc, v82, v84
    s_nop 1
    v_addc_co_u32 v83, vcc, 0, v83, vcc
nt_16:
    s_mov_b64 exec, -1
    ds_read_b64_tr_b16 v[76:77], v20 offset:30816
    ds_read_b64_tr_b16 v[78:79], v20 offset:31584
    s_waitcnt lgkmcnt(4)
    v_mfma_f32_16x16x32_bf16 v[176:179], v[68:71], v[32:35], v[176:179]
    v_mfma_f32_16x16x32_bf16 v[180:183], v[68:71], v[36:39], v[180:183]
    v_mfma_f32_16x16x32_bf16 v[184:187], v[68:71], v[40:43], v[184:187]
    v_mfma_f32_16x16x32_bf16 v[188:191], v[68:71], v[44:47], v[188:191]
    ds_read_b64_tr_b16 v[64:65], v18 offset:30848
    ds_read_b64_tr_b16 v[66:67], v18 offset:31616
    s_waitcnt lgkmcnt(4)
    v_mfma_f32_16x16x32_bf16 v[192:195], v[32:35], v[72:75], v[192:195]
    v_mfma_f32_16x16x32_bf16 v[196:199], v[36:39], v[72:75], v[196:199]
    v_mfma_f32_16x16x32_bf16 v[200:203], v[40:43], v[72:75], v[200:203]
    v_mfma_f32_16x16x32_bf16 v[204:207], v[44:47], v[72:75], v[204:207]
    ds_read_b64_tr_b16 v[68:69], v20 offset:30880
    ds_read_b64_tr_b16 v[70:71], v20 offset:31648
    s_waitcnt lgkmcnt(4)
    v_mfma_f32_16x16x32_bf16 v[208:211], v[32:35], v[76:79], v[208:211]
    v_mfma_f32_16x16x32_bf16 v[212:215], v[36:39], v[76:79], v[212:215]
    v_mfma_f32_16x16x32_bf16 v[216:219], v[40:43], v[76:79], v[216:219]
    v_mfma_f32_16x16x32_bf16 v[220:223], v[44:47], v[76:79], v[220:223]
    v_add_u32 v14, s38, v13
    v_add_u32 v16, s38, v15
    v_add_u32 v18, s38, v17
    v_add_u32 v20, s38, v19
    s_add_u32 s38, s38, 36864
    s_cmp_eq_u32 s38, 147456
    s_cselect_b32 s38, 0, s38
    ds_read_b128 v[48:51], v14 offset:0
    ds_read_b128 v[52:55], v14 offset:1024
    ds_read_b128 v[56:59], v14 offset:2048
    ds_read_b128 v[60:63], v14 offset:3072
    ds_read_b64_tr_b16 v[72:73], v16 offset:16544
    ds_read_b64_tr_b16 v[74:75], v16 offset:18336
    s_waitcnt lgkmcnt(8)
    v_mfma_f32_16x16x32_bf16 v[224:227], v[32:35], v[64:67], v[224:227]
    v_mfma_f32_16x16x32_bf16 v[228:231], v[36:39], v[64:67], v[228:231]
    v_mfma_f32_16x16x32_bf16 v[232:235], v[40:43], v[64:67], v[232:235]
    v_mfma_f32_16x16x32_bf16 v[236:239], v[44:47], v[64:67], v[236:239]
    ds_read_b64_tr_b16 v[76:77], v16 offset:16576
    ds_read_b64_tr_b16 v[78:79], v16 offset:18368
    s_waitcnt lgkmcnt(8)
    v_mfma_f32_16x16x32_bf16 v[240:243], v[32:35], v[68:71], v[240:243]
    v_mfma_f32_16x16x32_bf16 v[244:247], v[36:39], v[68:71], v[244:247]
    v_mfma_f32_16x16x32_bf16 v[248:251], v[40:43], v[68:71], v[248:251]
    v_mfma_f32_16x16x32_bf16 v[252:255], v[44:47], v[68:71], v[252:255]
    s_waitcnt vmcnt(6)
    s_barrier
    ds_read_b64_tr_b16 v[64:65], v16 offset:23712
    ds_read_b64_tr_b16 v[66:67], v16 offset:25504
    s_waitcnt lgkmcnt(4)
    v_mfma_f32_16x16x32_bf16 v[96:99], v[72:75], v[48:51], v[96:99]
    v_mfma_f32_16x16x32_bf16 v[100:103], v[72:75], v[52:55], v[100:103]
    v_mfma_f32_16x16x32_bf16 v[104:107], v[72:75], v[56:59], v[104:107]
    v_mfma_f32_16x16x32_bf16 v[108:111], v[72:75], v[60:63], v[108:111]
    s_add_u32 m0, s37, s76
    s_nop 0
    buffer_load_dwordx4 v6, s[40:43], s64 offen lds
    s_add_u32 s64, s64, s70
    ds_read_b64_tr_b16 v[68:69], v16 offset:23744
    ds_read_b64_tr_b16 v[70:71], v16 offset:25536
    s_waitcnt lgkmcnt(4)
    v_mfma_f32_16x16x32_bf16 v[112:115], v[76:79], v[48:51], v[112:115]
    v_mfma_f32_16x16x32_bf16 v[116:119], v[76:79], v[52:55], v[116:119]
    v_mfma_f32_16x16x32_bf16 v[120:123], v[76:79], v[56:59], v[120:123]
    v_mfma_f32_16x16x32_bf16 v[124:127], v[76:79], v[60:63], v[124:127]
    s_add_u32 m0, s37, s77
    s_nop 0
    buffer_load_dwordx4 v7, s[44:47], s65 offen lds
    s_add_u32 s65, s65, s71
    ds_read_b64_tr_b16 v[72:73], v18 offset:30720
    ds_read_b64_tr_b16 v[74:75], v18 offset:31488
    s_waitcnt lgkmcnt(4)
    v_mfma_f32_16x16x32_bf16 v[128:131], v[64:67], v[48:51], v[128:131]
    v_mfma_f32_16x16x32_bf16 v[132:135], v[64:67], v[52:55], v[132:135]
    v_mfma_f32_16x16x32_bf16 v[136:139], v[64:67], v[56:59], v[136:139]
    v_mfma_f32_16x16x32_bf16 v[140:143], v[64:67], v[60:63], v[140:143]
    s_add_u32 m0, s37, s78
    s_nop 0
    buffer_load_dwordx4 v8, s[48:51], s66 offen lds
    s_add_u32 s66, s66, s72
    ds_read_b64_tr_b16 v[76:77], v20 offset:30752
    ds_read_b64_tr_b16 v[78:79], v20 offset:31520
    s_waitcnt lgkmcnt(4)
    v_mfma_f32_16x16x32_bf16 v[144:147], v[68:71], v[48:51], v[144:147]
    v_mfma_f32_16x16x32_bf16 v[148:151], v[68:71], v[52:55], v[148:151]
    v_mfma_f32_16x16x32_bf16 v[152:155], v[68:71], v[56:59], v[152:155]
    v_mfma_f32_16x16x32_bf16 v[156:159], v[68:71], v[60:63], v[156:159]
    s_add_u32 m0, s37, s79
    s_nop 0
    buffer_load_dwordx4 v9, s[52:55], s67 offen lds
    s_add_u32 s67, s67, s73
    ds_read_b64_tr_b16 v[64:65], v18 offset:30784
    ds_read_b64_tr_b16 v[66:67], v18 offset:31552
    s_waitcnt lgkmcnt(4)
    v_mfma_f32_16x16x32_bf16 v[160:163], v[72:75], v[48:51], v[160:163]
    v_mfma_f32_16x16x32_bf16 v[164:167], v[72:75], v[52:55], v[164:167]
    v_mfma_f32_16x16x32_bf16 v[168:171], v[72:75], v[56:59], v[168:171]
    v_mfma_f32_16x16x32_bf16 v[172:175], v[72:75], v[60:63], v[172:175]
    s_add_u32 s37, s37, 36864
    s_cmp_eq_u32 s37, 147456
    s_cselect_b32 s37, 0, s37
    s_mov_b64 exec, 15
    global_load_dword v85, v[82:83], off
    s_cmp_lt_u32 s39, 3
    s_cbranch_scc1 nt_17
    v_add_co_u32 v82, vcc, v82, v84
    s_nop 1
    v_addc_co_u32 v83, vcc, 0, v83, vcc
nt_17:
    s_mov_b64 exec, -1
    ds_read_b64_tr_b16 v[68:69], v20 offset:30816
    ds_read_b64_tr_b16 v[70:71], v20 offset:31584
    s_waitcnt lgkmcnt(4)
    v_mfma_f32_16x16x32_bf16 v[176:179], v[76:79], v[48:51], v[176:179]
    v_mfma_f32_16x16x32_bf16 v[180:183], v[76:79], v[52:55], v[180:183]
    v_mfma_f32_16x16x32_bf16 v[184:187], v[76:79], v[56:59], v[184:187]
    v_mfma_f32_16x16x32_bf16 v[188:191], v[76:79], v[60:63], v[188:191]
    ds_read_b64_tr_b16 v[72:73], v18 offset:30848
    ds_read_b64_tr_b16 v[74:75], v18 offset:31616
    s_waitcnt lgkmcnt(4)
    v_mfma_f32_16x16x32_bf16 v[192:195], v[48:51], v[64:67], v[192:195]
    v_mfma_f32_16x16x32_bf16 v[196:199], v[52:55], v[64:67], v[196:199]
    v_mfma_f32_16x16x32_bf16 v[200:203], v[56:59], v[64:67], v[200:203]
    v_mfma_f32_16x16x32_bf16 v[204:207], v[60:63], v[64:67], v[204:207]
    ds_read_b64_tr_b16 v[76:77], v20 offset:30880
    ds_read_b64_tr_b16 v[78:79], v20 offset:31648
    s_waitcnt lgkmcnt(4)
    v_mfma_f32_16x16x32_bf16 v[208:211], v[48:51], v[68:71], v[208:211]
    v_mfma_f32_16x16x32_bf16 v[212:215], v[52:55], v[68:71], v[212:215]
    v_mfma_f32_16x16x32_bf16 v[216:219], v[56:59], v[68:71], v[216:219]
    v_mfma_f32_16x16x32_bf16 v[220:223], v[60:63], v[68:71], v[220:223]
    v_add_u32 v14, s38, v13
    v_add_u32 v16, s38, v15
    v_add_u32 v18, s38, v17
    v_add_u32 v20, s38, v19
    s_add_u32 s38, s38, 36864
    s_cmp_eq_u32 s38, 147456
    s_cselect_b32 s38, 0, s38
    ds_read_b128 v[32:35], v14 offset:0
    ds_read_b128 v[36:39], v14 offset:1024
    ds_read_b128 v[40:43], v14 offset:2048
    ds_read_b128 v[44:47], v14 offset:3072
    ds_read_b64_tr_b16 v[64:65], v16 offset:16544
    ds_read_b64_tr_b16 v[66:67], v16 offset:18336
    s_waitcnt lgkmcnt(8)
    v_mfma_f32_16x16x32_bf16 v[224:227], v[48:51], v[72:75], v[224:227]
    v_mfma_f32_16x16x32_bf16 v[228:231], v[52:55], v[72:75], v[228:231]
    v_mfma_f32_16x16x32_bf16 v[232:235], v[56:59], v[72:75], v[232:235]
    v_mfma_f32_16x16x32_bf16 v[236:239], v[60:63], v[72:75], v[236:239]
    ds_read_b64_tr_b16 v[68:69], v16 offset:16576
    ds_read_b64_tr_b16 v[70:71], v16 offset:18368
    s_waitcnt lgkmcnt(8)
    v_mfma_f32_16x16x32_bf16 v[240:243], v[48:51], v[76:79], v[240:243]
    v_mfma_f32_16x16x32_bf16 v[244:247], v[52:55], v[76:79], v[244:247]
    v_mfma_f32_16x16x32_bf16 v[248:251], v[56:59], v[76:79], v[248:251]
    v_mfma_f32_16x16x32_bf16 v[252:255], v[60:63], v[76:79], v[252:255]
    s_sub_u32 s39, s39, 1
    s_cmp_lg_u32 s39, 0
    s_cbranch_scc1 k1_kernel_loop1
    s_waitcnt vmcnt(6)
    s_barrier
    ds_read_b64_tr_b16 v[72:73], v16 offset:23712
    ds_read_b64_tr_b16 v[74:75], v16 offset:25504
    s_waitcnt lgkmcnt(4)
    v_mfma_f32_16x16x32_bf16 v[96:99], v[64:67], v[32:35], v[96:99]
    v_mfma_f32_16x16x32_bf16 v[100:103], v[64:67], v[36:39], v[100:103]
    v_mfma_f32_16x16x32_bf16 v[104:107], v[64:67], v[40:43], v[104:107]
    v_mfma_f32_16x16x32_bf16 v[108:111], v[64:67], v[44:47], v[108:111]
    s_add_u32 m0, s37, s76
    s_nop 0
    buffer_load_dwordx4 v6, s[40:43], s64 offen lds
    s_add_u32 s64, s64, s70
    ds_read_b64_tr_b16 v[76:77], v16 offset:23744
    ds_read_b64_tr_b16 v[78:79], v16 offset:25536
    s_waitcnt lgkmcnt(4)
    v_mfma_f32_16x16x32_bf16 v[112:115], v[68:71], v[32:35], v[112:115]
    v_mfma_f32_16x16x32_bf16 v[116:119], v[68:71], v[36:39], v[116:119]
    v_mfma_f32_16x16x32_bf16 v[120:123], v[68:71], v[40:43], v[120:123]
    v_mfma_f32_16x16x32_bf16 v[124:127], v[68:71], v[44:47], v[124:127]
    s_add_u32 m0, s37, s77
    s_nop 0
    buffer_load_dwordx4 v7, s[44:47], s65 offen lds
    s_add_u32 s65, s65, s71
    ds_read_b64_tr_b16 v[64:65], v18 offset:30720
    ds_read_b64_tr_b16 v[66:67], v18 offset:31488
    s_waitcnt lgkmcnt(4)
    v_mfma_f32_16x16x32_bf16 v[128:131], v[72:75], v[32:35], v[128:131]
    v_mfma_f32_16x16x32_bf16 v[132:135], v[72:75], v[36:39], v[132:135]
    v_mfma_f32_16x16x32_bf16 v[136:139], v[72:75], v[40:43], v[136:139]
    v_mfma_f32_16x16x32_bf16 v[140:143], v[72:75], v[44:47], v[140:143]
    s_add_u32 m0, s37, s78
    s_nop 0
    buffer_load_dwordx4 v8, s[48:51], s66 offen lds
    s_add_u32 s66, s66, s72
    ds_read_b64_tr_b16 v[68:69], v20 offset:30752
    ds_read_b64_tr_b16 v[70:71], v20 offset:31520
    s_waitcnt lgkmcnt(4)
    v_mfma_f32_16x16x32_bf16 v[144:147], v[76:79], v[32:35], v[144:147]
    v_mfma_f32_16x16x32_bf16 v[148:151], v[76:79], v[36:39], v[148:151]
    v_mfma_f32_16x16x32_bf16 v[152:155], v[76:79], v[40:43], v[152:155]
    v_mfma_f32_16x16x32_bf16 v[156:159], v[76:79], v[44:47], v[156:159]
    s_add_u32 m0, s37, s79
    s_nop 0
    buffer_load_dwordx4 v9, s[52:55], s67 offen lds
    s_add_u32 s67, s67, s73
    ds_read_b64_tr_b16 v[72:73], v18 offset:30784
    ds_read_b64_tr_b16 v[74:75], v18 offset:31552
    s_waitcnt lgkmcnt(4)
    v_mfma_f32_16x16x32_bf16 v[160:163], v[64:67], v[32:35], v[160:163]
    v_mfma_f32_16x16x32_bf16 v[164:167], v[64:67], v[36:39], v[164:167]
    v_mfma_f32_16x16x32_bf16 v[168:171], v[64:67], v[40:43], v[168:171]
    v_mfma_f32_16x16x32_bf16 v[172:175], v[64:67], v[44:47], v[172:175]
    s_add_u32 s37, s37, 36864
    s_cmp_eq_u32 s37, 147456
    s_cselect_b32 s37, 0, s37
    ds_read_b64_tr_b16 v[76:77], v20 offset:30816
    ds_read_b64_tr_b16 v[78:79], v20 offset:31584
    s_waitcnt lgkmcnt(4)
    v_mfma_f32_16x16x32_bf16 v[176:179], v[68:71], v[32:35], v[176:179]
    v_mfma_f32_16x16x32_bf16 v[180:183], v[68:71], v[36:39], v[180:183]
    v_mfma_f32_16x16x32_bf16 v[184:187], v[68:71], v[40:43], v[184:187]
    v_mfma_f32_16x16x32_bf16 v[188:191], v[68:71], v[44:47], v[188:191]
    ds_read_b64_tr_b16 v[64:65], v18 offset:30848
    ds_read_b64_tr_b16 v[66:67], v18 offset:31616
    s_waitcnt lgkmcnt(4)
    v_mfma_f32_16x16x32_bf16 v[192:195], v[32:35], v[72:75], v[192:195]
    v_mfma_f32_16x16x32_bf16 v[196:199], v[36:39], v[72:75], v[196:199]
    v_mfma_f32_16x16x32_bf16 v[200:203], v[40:43], v[72:75], v[200:203]
    v_mfma_f32_16x16x32_bf16 v[204:207], v[44:47], v[72:75], v[204:207]
    ds_read_b64_tr_b16 v[68:69], v20 offset:30880
    ds_read_b64_tr_b16 v[70:71], v20 offset:31648
    s_waitcnt lgkmcnt(4)
    v_mfma_f32_16x16x32_bf16 v[208:211], v[32:35], v[76:79], v[208:211]
    v_mfma_f32_16x16x32_bf16 v[212:215], v[36:39], v[76:79], v[212:215]
    v_mfma_f32_16x16x32_bf16 v[216:219], v[40:43], v[76:79], v[216:219]
    v_mfma_f32_16x16x32_bf16 v[220:223], v[44:47], v[76:79], v[220:223]
    v_add_u32 v14, s38, v13
    v_add_u32 v16, s38, v15
    v_add_u32 v18, s38, v17
    v_add_u32 v20, s38, v19
    s_add_u32 s38, s38, 36864
    s_cmp_eq_u32 s38, 147456
    s_cselect_b32 s38, 0, s38
    ds_read_b128 v[48:51], v14 offset:0
    ds_read_b128 v[52:55], v14 offset:1024
    ds_read_b128 v[56:59], v14 offset:2048
    ds_read_b128 v[60:63], v14 offset:3072
    ds_read_b64_tr_b16 v[72:73], v16 offset:16544
    ds_read_b64_tr_b16 v[74:75], v16 offset:18336
    s_waitcnt lgkmcnt(8)
    v_mfma_f32_16x16x32_bf16 v[224:227], v[32:35], v[64:67], v[224:227]
    v_mfma_f32_16x16x32_bf16 v[228:231], v[36:39], v[64:67], v[228:231]
    v_mfma_f32_16x16x32_bf16 v[232:235], v[40:43], v[64:67], v[232:235]
    v_mfma_f32_16x16x32_bf16 v[236:239], v[44:47], v[64:67], v[236:239]
    ds_read_b64_tr_b16 v[76:77], v16 offset:16576
    ds_read_b64_tr_b16 v[78:79], v16 offset:18368
    s_waitcnt lgkmcnt(8)
    v_mfma_f32_16x16x32_bf16 v[240:243], v[32:35], v[68:71], v[240:243]
    v_mfma_f32_16x16x32_bf16 v[244:247], v[36:39], v[68:71], v[244:247]
    v_mfma_f32_16x16x32_bf16 v[248:251], v[40:43], v[68:71], v[248:251]
    v_mfma_f32_16x16x32_bf16 v[252:255], v[44:47], v[68:71], v[252:255]
    s_waitcnt vmcnt(5)
    s_barrier
    ds_read_b64_tr_b16 v[64:65], v16 offset:23712
    ds_read_b64_tr_b16 v[66:67], v16 offset:25504
    s_waitcnt lgkmcnt(4)
    v_mfma_f32_16x16x32_bf16 v[96:99], v[72:75], v[48:51], v[96:99]
    v_mfma_f32_16x16x32_bf16 v[100:103], v[72:75], v[52:55], v[100:103]
    v_mfma_f32_16x16x32_bf16 v[104:107], v[72:75], v[56:59], v[104:107]
    v_mfma_f32_16x16x32_bf16 v[108:111], v[72:75], v[60:63], v[108:111]
    s_lshl_b32 s82, s2, 3
    s_add_u32 s82, s82, s32
    s_lshl_b32 s82, s82, 10
    v_lshlrev_b32 v80, 4, v1
    v_add_u32 v80, s82, v80
    s_mov_b32 s40, s26
    s_mov_b32 s41, s27
    s_mov_b32 s42, 7340032
    s_mov_b32 s44, s24
    s_mov_b32 s45, s25
    s_mov_b32 s46, 2097152
    s_mov_b32 s82, 0
    buffer_load_dwordx4 v[84:87], v80, s[40:43], s82 offen
    s_add_u32 s82, s82, 0x200000
    ds_read_b64_tr_b16 v[68:69], v16 offset:23744
    ds_read_b64_tr_b16 v[70:71], v16 offset:25536
    s_waitcnt lgkmcnt(4)
    v_mfma_f32_16x16x32_bf16 v[112:115], v[76:79], v[48:51], v[112:115]
    v_mfma_f32_16x16x32_bf16 v[116:119], v[76:79], v[52:55], v[116:119]
    v_mfma_f32_16x16x32_bf16 v[120:123], v[76:79], v[56:59], v[120:123]
    v_mfma_f32_16x16x32_bf16 v[124:127], v[76:79], v[60:63], v[124:127]
    buffer_load_dwordx4 v[84:87], v80, s[40:43], s82 offen
    s_add_u32 s82, s82, 0x200000
    ds_read_b64_tr_b16 v[72:73], v18 offset:30720
    ds_read_b64_tr_b16 v[74:75], v18 offset:31488
    s_waitcnt lgkmcnt(4)
    v_mfma_f32_16x16x32_bf16 v[128:131], v[64:67], v[48:51], v[128:131]
    v_mfma_f32_16x16x32_bf16 v[132:135], v[64:67], v[52:55], v[132:135]
    v_mfma_f32_16x16x32_bf16 v[136:139], v[64:67], v[56:59], v[136:139]
    v_mfma_f32_16x16x32_bf16 v[140:143], v[64:67], v[60:63], v[140:143]
    buffer_load_dwordx4 v[84:87], v80, s[40:43], s82 offen
    s_add_u32 s82, s82, 0x200000
    ds_read_b64_tr_b16 v[76:77], v20 offset:30752
    ds_read_b64_tr_b16 v[78:79], v20 offset:31520
    s_waitcnt lgkmcnt(4)
    v_mfma_f32_16x16x32_bf16 v[144:147], v[68:71], v[48:51], v[144:147]
    v_mfma_f32_16x16x32_bf16 v[148:151], v[68:71], v[52:55], v[148:151]
    v_mfma_f32_16x16x32_bf16 v[152:155], v[68:71], v[56:59], v[152:155]
    v_mfma_f32_16x16x32_bf16 v[156:159], v[68:71], v[60:63], v[156:159]
    buffer_load_dwordx4 v[84:87], v80, s[40:43], s82 offen
    s_add_u32 s82, s82, 0x200000
    ds_read_b64_tr_b16 v[64:65], v18 offset:30784
    ds_read_b64_tr_b16 v[66:67], v18 offset:31552
    s_waitcnt lgkmcnt(4)
    v_mfma_f32_16x16x32_bf16 v[160:163], v[72:75], v[48:51], v[160:163]
    v_mfma_f32_16x16x32_bf16 v[164:167], v[72:75], v[52:55], v[164:167]
    v_mfma_f32_16x16x32_bf16 v[168:171], v[72:75], v[56:59], v[168:171]
    v_mfma_f32_16x16x32_bf16 v[172:175], v[72:75], v[60:63], v[172:175]
    buffer_load_dwordx4 v[84:87], v80, s[44:47], 0 offen
    ds_read_b64_tr_b16 v[68:69], v20 offset:30816
    ds_read_b64_tr_b16 v[70:71], v20 offset:31584
    s_waitcnt lgkmcnt(4)
    v_mfma_f32_16x16x32_bf16 v[176:179], v[76:79], v[48:51], v[176:179]
    v_mfma_f32_16x16x32_bf16 v[180:183], v[76:79], v[52:55], v[180:183]
    v_mfma_f32_16x16x32_bf16 v[184:187], v[76:79], v[56:59], v[184:187]
    v_mfma_f32_16x16x32_bf16 v[188:191], v[76:79], v[60:63], v[188:191]
    ds_read_b64_tr_b16 v[72:73], v18 offset:30848
    ds_read_b64_tr_b16 v[74:75], v18 offset:31616
    s_waitcnt lgkmcnt(4)
    v_mfma_f32_16x16x32_bf16 v[192:195], v[48:51], v[64:67], v[192:195]
    v_mfma_f32_16x16x32_bf16 v[196:199], v[52:55], v[64:67], v[196:199]
    v_mfma_f32_16x16x32_bf16 v[200:203], v[56:59], v[64:67], v[200:203]
    v_mfma_f32_16x16x32_bf16 v[204:207], v[60:63], v[64:67], v[204:207]
    ds_read_b64_tr_b16 v[76:77], v20 offset:30880
    ds_read_b64_tr_b16 v[78:79], v20 offset:31648
    s_waitcnt lgkmcnt(4)
    v_mfma_f32_16x16x32_bf16 v[208:211], v[48:51], v[68:71], v[208:211]
    v_mfma_f32_16x16x32_bf16 v[212:215], v[52:55], v[68:71], v[212:215]
    v_mfma_f32_16x16x32_bf16 v[216:219], v[56:59], v[68:71], v[216:219]
    v_mfma_f32_16x16x32_bf16 v[220:223], v[60:63], v[68:71], v[220:223]
    v_add_u32 v14, s38, v13
    v_add_u32 v16, s38, v15
    v_add_u32 v18, s38, v17
    v_add_u32 v20, s38, v19
    s_add_u32 s38, s38, 36864
    s_cmp_eq_u32 s38, 147456
    s_cselect_b32 s38, 0, s38
    ds_read_b128 v[32:35], v14 offset:0
    ds_read_b128 v[36:39], v14 offset:1024
    ds_read_b128 v[40:43], v14 offset:2048
    ds_read_b128 v[44:47], v14 offset:3072
    ds_read_b64_tr_b16 v[64:65], v16 offset:16544
    ds_read_b64_tr_b16 v[66:67], v16 offset:18336
    s_waitcnt lgkmcnt(8)
    v_mfma_f32_16x16x32_bf16 v[224:227], v[48:51], v[72:75], v[224:227]
    v_mfma_f32_16x16x32_bf16 v[228:231], v[52:55], v[72:75], v[228:231]
    v_mfma_f32_16x16x32_bf16 v[232:235], v[56:59], v[72:75], v[232:235]
    v_mfma_f32_16x16x32_bf16 v[236:239], v[60:63], v[72:75], v[236:239]
    ds_read_b64_tr_b16 v[68:69], v16 offset:16576
    ds_read_b64_tr_b16 v[70:71], v16 offset:18368
    s_waitcnt lgkmcnt(8)
    v_mfma_f32_16x16x32_bf16 v[240:243], v[48:51], v[76:79], v[240:243]
    v_mfma_f32_16x16x32_bf16 v[244:247], v[52:55], v[76:79], v[244:247]
    v_mfma_f32_16x16x32_bf16 v[248:251], v[56:59], v[76:79], v[248:251]
    v_mfma_f32_16x16x32_bf16 v[252:255], v[60:63], v[76:79], v[252:255]
    s_waitcnt vmcnt(5)
    s_barrier
    ds_read_b64_tr_b16 v[72:73], v16 offset:23712
    ds_read_b64_tr_b16 v[74:75], v16 offset:25504
    s_waitcnt lgkmcnt(4)
    v_mfma_f32_16x16x32_bf16 v[96:99], v[64:67], v[32:35], v[96:99]
    v_mfma_f32_16x16x32_bf16 v[100:103], v[64:67], v[36:39], v[100:103]
    v_mfma_f32_16x16x32_bf16 v[104:107], v[64:67], v[40:43], v[104:107]
    v_mfma_f32_16x16x32_bf16 v[108:111], v[64:67], v[44:47], v[108:111]
    ds_read_b64_tr_b16 v[76:77], v16 offset:23744
    ds_read_b64_tr_b16 v[78:79], v16 offset:25536
    s_waitcnt lgkmcnt(4)
    v_mfma_f32_16x16x32_bf16 v[112:115], v[68:71], v[32:35], v[112:115]
    v_mfma_f32_16x16x32_bf16 v[116:119], v[68:71], v[36:39], v[116:119]
    v_mfma_f32_16x16x32_bf16 v[120:123], v[68:71], v[40:43], v[120:123]
    v_mfma_f32_16x16x32_bf16 v[124:127], v[68:71], v[44:47], v[124:127]
    ds_read_b64_tr_b16 v[64:65], v18 offset:30720
    ds_read_b64_tr_b16 v[66:67], v18 offset:31488
    s_waitcnt lgkmcnt(4)
    v_mfma_f32_16x16x32_bf16 v[128:131], v[72:75], v[32:35], v[128:131]
    v_mfma_f32_16x16x32_bf16 v[132:135], v[72:75], v[36:39], v[132:135]
    v_mfma_f32_16x16x32_bf16 v[136:139], v[72:75], v[40:43], v[136:139]
    v_mfma_f32_16x16x32_bf16 v[140:143], v[72:75], v[44:47], v[140:143]
    ds_read_b64_tr_b16 v[68:69], v20 offset:30752
    ds_read_b64_tr_b16 v[70:71], v20 offset:31520
    s_waitcnt lgkmcnt(4)
    v_mfma_f32_16x16x32_bf16 v[144:147], v[76:79], v[32:35], v[144:147]
    v_mfma_f32_16x16x32_bf16 v[148:151], v[76:79], v[36:39], v[148:151]
    v_mfma_f32_16x16x32_bf16 v[152:155], v[76:79], v[40:43], v[152:155]
    v_mfma_f32_16x16x32_bf16 v[156:159], v[76:79], v[44:47], v[156:159]
    ds_read_b64_tr_b16 v[72:73], v18 offset:30784
    ds_read_b64_tr_b16 v[74:75], v18 offset:31552
    s_waitcnt lgkmcnt(4)
    v_mfma_f32_16x16x32_bf16 v[160:163], v[64:67], v[32:35], v[160:163]
    v_mfma_f32_16x16x32_bf16 v[164:167], v[64:67], v[36:39], v[164:167]
    v_mfma_f32_16x16x32_bf16 v[168:171], v[64:67], v[40:43], v[168:171]
    v_mfma_f32_16x16x32_bf16 v[172:175], v[64:67], v[44:47], v[172:175]
    ds_read_b64_tr_b16 v[76:77], v20 offset:30816
    ds_read_b64_tr_b16 v[78:79], v20 offset:31584
    s_waitcnt lgkmcnt(4)
    v_mfma_f32_16x16x32_bf16 v[176:179], v[68:71], v[32:35], v[176:179]
    v_mfma_f32_16x16x32_bf16 v[180:183], v[68:71], v[36:39], v[180:183]
    v_mfma_f32_16x16x32_bf16 v[184:187], v[68:71], v[40:43], v[184:187]
    v_mfma_f32_16x16x32_bf16 v[188:191], v[68:71], v[44:47], v[188:191]
    ds_read_b64_tr_b16 v[64:65], v18 offset:30848
    ds_read_b64_tr_b16 v[66:67], v18 offset:31616
    s_waitcnt lgkmcnt(4)
    v_mfma_f32_16x16x32_bf16 v[192:195], v[32:35], v[72:75], v[192:195]
    v_mfma_f32_16x16x32_bf16 v[196:199], v[36:39], v[72:75], v[196:199]
    v_mfma_f32_16x16x32_bf16 v[200:203], v[40:43], v[72:75], v[200:203]
    v_mfma_f32_16x16x32_bf16 v[204:207], v[44:47], v[72:75], v[204:207]
    ds_read_b64_tr_b16 v[68:69], v20 offset:30880
    ds_read_b64_tr_b16 v[70:71], v20 offset:31648
    s_waitcnt lgkmcnt(4)
    v_mfma_f32_16x16x32_bf16 v[208:211], v[32:35], v[76:79], v[208:211]
    v_mfma_f32_16x16x32_bf16 v[212:215], v[36:39], v[76:79], v[212:215]
    v_mfma_f32_16x16x32_bf16 v[216:219], v[40:43], v[76:79], v[216:219]
    v_mfma_f32_16x16x32_bf16 v[220:223], v[44:47], v[76:79], v[220:223]
    v_add_u32 v14, s38, v13
    v_add_u32 v16, s38, v15
    v_add_u32 v18, s38, v17
    v_add_u32 v20, s38, v19
    s_add_u32 s38, s38, 36864
    s_cmp_eq_u32 s38, 147456
    s_cselect_b32 s38, 0, s38
    ds_read_b128 v[48:51], v14 offset:0
    ds_read_b128 v[52:55], v14 offset:1024
    ds_read_b128 v[56:59], v14 offset:2048
    ds_read_b128 v[60:63], v14 offset:3072
    ds_read_b64_tr_b16 v[72:73], v16 offset:16544
    ds_read_b64_tr_b16 v[74:75], v16 offset:18336
    s_waitcnt lgkmcnt(8)
    v_mfma_f32_16x16x32_bf16 v[224:227], v[32:35], v[64:67], v[224:227]
    v_mfma_f32_16x16x32_bf16 v[228:231], v[36:39], v[64:67], v[228:231]
    v_mfma_f32_16x16x32_bf16 v[232:235], v[40:43], v[64:67], v[232:235]
    v_mfma_f32_16x16x32_bf16 v[236:239], v[44:47], v[64:67], v[236:239]
    ds_read_b64_tr_b16 v[76:77], v16 offset:16576
    ds_read_b64_tr_b16 v[78:79], v16 offset:18368
    s_waitcnt lgkmcnt(8)
    v_mfma_f32_16x16x32_bf16 v[240:243], v[32:35], v[68:71], v[240:243]
    v_mfma_f32_16x16x32_bf16 v[244:247], v[36:39], v[68:71], v[244:247]
    v_mfma_f32_16x16x32_bf16 v[248:251], v[40:43], v[68:71], v[248:251]
    v_mfma_f32_16x16x32_bf16 v[252:255], v[44:47], v[68:71], v[252:255]
    ds_read_b64_tr_b16 v[64:65], v16 offset:23712
    ds_read_b64_tr_b16 v[66:67], v16 offset:25504
    s_waitcnt lgkmcnt(4)
    v_mfma_f32_16x16x32_bf16 v[96:99], v[72:75], v[48:51], v[96:99]
    v_mfma_f32_16x16x32_bf16 v[100:103], v[72:75], v[52:55], v[100:103]
    v_mfma_f32_16x16x32_bf16 v[104:107], v[72:75], v[56:59], v[104:107]
    v_mfma_f32_16x16x32_bf16 v[108:111], v[72:75], v[60:63], v[108:111]
    ds_read_b64_tr_b16 v[68:69], v16 offset:23744
    ds_read_b64_tr_b16 v[70:71], v16 offset:25536
    s_waitcnt lgkmcnt(4)
    v_mfma_f32_16x16x32_bf16 v[112:115], v[76:79], v[48:51], v[112:115]
    v_mfma_f32_16x16x32_bf16 v[116:119], v[76:79], v[52:55], v[116:119]
    v_mfma_f32_16x16x32_bf16 v[120:123], v[76:79], v[56:59], v[120:123]
    v_mfma_f32_16x16x32_bf16 v[124:127], v[76:79], v[60:63], v[124:127]
    ds_read_b64_tr_b16 v[72:73], v18 offset:30720
    ds_read_b64_tr_b16 v[74:75], v18 offset:31488
    s_waitcnt lgkmcnt(4)
    v_mfma_f32_16x16x32_bf16 v[128:131], v[64:67], v[48:51], v[128:131]
    v_mfma_f32_16x16x32_bf16 v[132:135], v[64:67], v[52:55], v[132:135]
    v_mfma_f32_16x16x32_bf16 v[136:139], v[64:67], v[56:59], v[136:139]
    v_mfma_f32_16x16x32_bf16 v[140:143], v[64:67], v[60:63], v[140:143]
    ds_read_b64_tr_b16 v[76:77], v20 offset:30752
    ds_read_b64_tr_b16 v[78:79], v20 offset:31520
    s_waitcnt lgkmcnt(4)
    v_mfma_f32_16x16x32_bf16 v[144:147], v[68:71], v[48:51], v[144:147]
    v_mfma_f32_16x16x32_bf16 v[148:151], v[68:71], v[52:55], v[148:151]
    v_mfma_f32_16x16x32_bf16 v[152:155], v[68:71], v[56:59], v[152:155]
    v_mfma_f32_16x16x32_bf16 v[156:159], v[68:71], v[60:63], v[156:159]
    ds_read_b64_tr_b16 v[64:65], v18 offset:30784
    ds_read_b64_tr_b16 v[66:67], v18 offset:31552
    s_waitcnt lgkmcnt(4)
    v_mfma_f32_16x16x32_bf16 v[160:163], v[72:75], v[48:51], v[160:163]
    v_mfma_f32_16x16x32_bf16 v[164:167], v[72:75], v[52:55], v[164:167]
    v_mfma_f32_16x16x32_bf16 v[168:171], v[72:75], v[56:59], v[168:171]
    v_mfma_f32_16x16x32_bf16 v[172:175], v[72:75], v[60:63], v[172:175]
    ds_read_b64_tr_b16 v[68:69], v20 offset:30816
    ds_read_b64_tr_b16 v[70:71], v20 offset:31584
    s_waitcnt lgkmcnt(4)
    v_mfma_f32_16x16x32_bf16 v[176:179], v[76:79], v[48:51], v[176:179]
    v_mfma_f32_16x16x32_bf16 v[180:183], v[76:79], v[52:55], v[180:183]
    v_mfma_f32_16x16x32_bf16 v[184:187], v[76:79], v[56:59], v[184:187]
    v_mfma_f32_16x16x32_bf16 v[188:191], v[76:79], v[60:63], v[188:191]
    ds_read_b64_tr_b16 v[72:73], v18 offset:30848
    ds_read_b64_tr_b16 v[74:75], v18 offset:31616
    s_waitcnt lgkmcnt(4)
    v_mfma_f32_16x16x32_bf16 v[192:195], v[48:51], v[64:67], v[192:195]
    v_mfma_f32_16x16x32_bf16 v[196:199], v[52:55], v[64:67], v[196:199]
    v_mfma_f32_16x16x32_bf16 v[200:203], v[56:59], v[64:67], v[200:203]
    v_mfma_f32_16x16x32_bf16 v[204:207], v[60:63], v[64:67], v[204:207]
    ds_read_b64_tr_b16 v[76:77], v20 offset:30880
    ds_read_b64_tr_b16 v[78:79], v20 offset:31648
    s_waitcnt lgkmcnt(4)
    v_mfma_f32_16x16x32_bf16 v[208:211], v[48:51], v[68:71], v[208:211]
    v_mfma_f32_16x16x32_bf16 v[212:215], v[52:55], v[68:71], v[212:215]
    v_mfma_f32_16x16x32_bf16 v[216:219], v[56:59], v[68:71], v[216:219]
    v_mfma_f32_16x16x32_bf16 v[220:223], v[60:63], v[68:71], v[220:223]
    s_waitcnt lgkmcnt(2)
    v_mfma_f32_16x16x32_bf16 v[224:227], v[48:51], v[72:75], v[224:227]
    v_mfma_f32_16x16x32_bf16 v[228:231], v[52:55], v[72:75], v[228:231]
    v_mfma_f32_16x16x32_bf16 v[232:235], v[56:59], v[72:75], v[232:235]
    v_mfma_f32_16x16x32_bf16 v[236:239], v[60:63], v[72:75], v[236:239]
    s_waitcnt lgkmcnt(0)
    v_mfma_f32_16x16x32_bf16 v[240:243], v[48:51], v[76:79], v[240:243]
    v_mfma_f32_16x16x32_bf16 v[244:247], v[52:55], v[76:79], v[244:247]
    v_mfma_f32_16x16x32_bf16 v[248:251], v[56:59], v[76:79], v[248:251]
    v_mfma_f32_16x16x32_bf16 v[252:255], v[60:63], v[76:79], v[252:255]
    s_setprio 3
    s_nop 7
    s_nop 7
    s_barrier
    s_mov_b32 s40, s20
    s_mov_b32 s41, s21
    s_mov_b32 s42, 256
    s_mov_b32 s43, 0x00020000
    s_mov_b32 s44, s18
    s_mov_b32 s45, s19
    s_mov_b32 s46, 2048
    s_mov_b32 s47, 0x00020000
    s_lshl_b32 s82, s30, 8
    s_lshl_b32 s83, s33, 6
    s_add_u32 s82, s82, s83
    s_mul_i32 s49, s82, 9216
    s_add_u32 s48, s49, s35
    s_add_u32 s48, s48, 2048
    v_mul_u32_u24 v21, 9216, v5
    v_lshlrev_b32 v22, 3, v2
    v_add_u32 v21, v21, v22
    v_mul_u32_u24 v19, 9216, v5
    v_and_b32 v22, 1, v2
    v_lshlrev_b32 v22, 5, v22
    v_add_u32 v19, v19, v22
    v_lshrrev_b32 v22, 1, v2
    v_lshlrev_b32 v22, 4, v22
    v_add_u32 v19, v19, v22
    v_mov_b32 v48, 0x3f803f80
    v_mov_b32 v49, 0x3f803f80
    v_mov_b32 v50, 0x3f803f80
    v_mov_b32 v51, 0x3f803f80
    v_cvt_pk_bf16_f32 v80, v192, v193
    v_lshlrev_b32 v81, 16, v80
    v_and_b32 v80, 0xffff0000, v80
    v_mul_f32 v82, 0x3fb8aa3b, v81
    v_mul_f32 v83, 0x3fb8aa3b, v80
    v_min_f32 v82, 0, v82
    v_min_f32 v83, 0, v83
    v_exp_f32 v82, v82
    v_exp_f32 v83, v83
    v_max_f32 v81, 0, v81
    v_max_f32 v80, 0, v80
    v_add_f32 v82, v82, v81
    v_add_f32 v83, v83, v80
    v_cvt_pk_bf16_f32 v80, v82, v83
    v_lshlrev_b32 v81, 16, v80
    v_and_b32 v80, 0xffff0000, v80
    v_add_f32 v81, 0x358637bd, v81
    v_add_f32 v80, 0x358637bd, v80
    v_cvt_pk_bf16_f32 v32, v81, v80
    v_cvt_pk_bf16_f32 v80, v194, v195
    v_lshlrev_b32 v81, 16, v80
    v_and_b32 v80, 0xffff0000, v80
    v_mul_f32 v82, 0x3fb8aa3b, v81
    v_mul_f32 v83, 0x3fb8aa3b, v80
    v_min_f32 v82, 0, v82
    v_min_f32 v83, 0, v83
    v_exp_f32 v82, v82
    v_exp_f32 v83, v83
    v_max_f32 v81, 0, v81
    v_max_f32 v80, 0, v80
    v_add_f32 v82, v82, v81
    v_add_f32 v83, v83, v80
    v_cvt_pk_bf16_f32 v80, v82, v83
    v_lshlrev_b32 v81, 16, v80
    v_and_b32 v80, 0xffff0000, v80
    v_add_f32 v81, 0x358637bd, v81
    v_add_f32 v80, 0x358637bd, v80
    v_cvt_pk_bf16_f32 v33, v81, v80
    v_cvt_pk_bf16_f32 v80, v196, v197
    v_lshlrev_b32 v81, 16, v80
    v_and_b32 v80, 0xffff0000, v80
    v_mul_f32 v82, 0x3fb8aa3b, v81
    v_mul_f32 v83, 0x3fb8aa3b, v80
    v_min_f32 v82, 0, v82
    v_min_f32 v83, 0, v83
    v_exp_f32 v82, v82
    v_exp_f32 v83, v83
    v_max_f32 v81, 0, v81
    v_max_f32 v80, 0, v80
    v_add_f32 v82, v82, v81
    v_add_f32 v83, v83, v80
    v_cvt_pk_bf16_f32 v80, v82, v83
    v_lshlrev_b32 v81, 16, v80
    v_and_b32 v80, 0xffff0000, v80
    v_add_f32 v81, 0x358637bd, v81
    v_add_f32 v80, 0x358637bd, v80
    v_cvt_pk_bf16_f32 v34, v81, v80
    v_cvt_pk_bf16_f32 v80, v198, v199
    v_lshlrev_b32 v81, 16, v80
    v_and_b32 v80, 0xffff0000, v80
    v_mul_f32 v82, 0x3fb8aa3b, v81
    v_mul_f32 v83, 0x3fb8aa3b, v80
    v_min_f32 v82, 0, v82
    v_min_f32 v83, 0, v83
    v_exp_f32 v82, v82
    v_exp_f32 v83, v83
    v_max_f32 v81, 0, v81
    v_max_f32 v80, 0, v80
    v_add_f32 v82, v82, v81
    v_add_f32 v83, v83, v80
    v_cvt_pk_bf16_f32 v80, v82, v83
    v_lshlrev_b32 v81, 16, v80
    v_and_b32 v80, 0xffff0000, v80
    v_add_f32 v81, 0x358637bd, v81
    v_add_f32 v80, 0x358637bd, v80
    v_cvt_pk_bf16_f32 v35, v81, v80
    v_cvt_pk_bf16_f32 v80, v208, v209
    v_lshlrev_b32 v81, 16, v80
    v_and_b32 v80, 0xffff0000, v80
    v_mul_f32 v82, 0x3fb8aa3b, v81
    v_mul_f32 v83, 0x3fb8aa3b, v80
    v_min_f32 v82, 0, v82
    v_min_f32 v83, 0, v83
    v_exp_f32 v82, v82
    v_exp_f32 v83, v83
    v_max_f32 v81, 0, v81
    v_max_f32 v80, 0, v80
    v_add_f32 v82, v82, v81
    v_add_f32 v83, v83, v80
    v_cvt_pk_bf16_f32 v80, v82, v83
    v_lshlrev_b32 v81, 16, v80
    v_and_b32 v80, 0xffff0000, v80
    v_add_f32 v81, 0x358637bd, v81
    v_add_f32 v80, 0x358637bd, v80
    v_cvt_pk_bf16_f32 v36, v81, v80
    v_cvt_pk_bf16_f32 v80, v210, v211
    v_lshlrev_b32 v81, 16, v80
    v_and_b32 v80, 0xffff0000, v80
    v_mul_f32 v82, 0x3fb8aa3b, v81
    v_mul_f32 v83, 0x3fb8aa3b, v80
    v_min_f32 v82, 0, v82
    v_min_f32 v83, 0, v83
    v_exp_f32 v82, v82
    v_exp_f32 v83, v83
    v_max_f32 v81, 0, v81
    v_max_f32 v80, 0, v80
    v_add_f32 v82, v82, v81
    v_add_f32 v83, v83, v80
    v_cvt_pk_bf16_f32 v80, v82, v83
    v_lshlrev_b32 v81, 16, v80
    v_and_b32 v80, 0xffff0000, v80
    v_add_f32 v81, 0x358637bd, v81
    v_add_f32 v80, 0x358637bd, v80
    v_cvt_pk_bf16_f32 v37, v81, v80
    v_cvt_pk_bf16_f32 v80, v212, v213
    v_lshlrev_b32 v81, 16, v80
    v_and_b32 v80, 0xffff0000, v80
    v_mul_f32 v82, 0x3fb8aa3b, v81
    v_mul_f32 v83, 0x3fb8aa3b, v80
    v_min_f32 v82, 0, v82
    v_min_f32 v83, 0, v83
    v_exp_f32 v82, v82
    v_exp_f32 v83, v83
    v_max_f32 v81, 0, v81
    v_max_f32 v80, 0, v80
    v_add_f32 v82, v82, v81
    v_add_f32 v83, v83, v80
    v_cvt_pk_bf16_f32 v80, v82, v83
    v_lshlrev_b32 v81, 16, v80
    v_and_b32 v80, 0xffff0000, v80
    v_add_f32 v81, 0x358637bd, v81
    v_add_f32 v80, 0x358637bd, v80
    v_cvt_pk_bf16_f32 v38, v81, v80
    v_cvt_pk_bf16_f32 v80, v214, v215
    v_lshlrev_b32 v81, 16, v80
    v_and_b32 v80, 0xffff0000, v80
    v_mul_f32 v82, 0x3fb8aa3b, v81
    v_mul_f32 v83, 0x3fb8aa3b, v80
    v_min_f32 v82, 0, v82
    v_min_f32 v83, 0, v83
    v_exp_f32 v82, v82
    v_exp_f32 v83, v83
    v_max_f32 v81, 0, v81
    v_max_f32 v80, 0, v80
    v_add_f32 v82, v82, v81
    v_add_f32 v83, v83, v80
    v_cvt_pk_bf16_f32 v80, v82, v83
    v_lshlrev_b32 v81, 16, v80
    v_and_b32 v80, 0xffff0000, v80
    v_add_f32 v81, 0x358637bd, v81
    v_add_f32 v80, 0x358637bd, v80
    v_cvt_pk_bf16_f32 v39, v81, v80
    v_cvt_pk_bf16_f32 v40, v224, v225
    v_cvt_pk_bf16_f32 v41, v226, v227
    v_cvt_pk_bf16_f32 v42, v228, v229
    v_cvt_pk_bf16_f32 v43, v230, v231
    v_cvt_pk_bf16_f32 v44, v240, v241
    v_cvt_pk_bf16_f32 v45, v242, v243
    v_cvt_pk_bf16_f32 v46, v244, v245
    v_cvt_pk_bf16_f32 v47, v246, v247
    s_nop 1
    v_mfma_f32_16x16x32_bf16 v[56:59], v[32:35], v[40:43], 0
    v_mfma_f32_16x16x32_bf16 v[60:63], v[32:35], v[44:47], 0
    v_mfma_f32_16x16x32_bf16 v[72:75], v[32:35], v[48:51], 0
    v_mfma_f32_16x16x32_bf16 v[64:67], v[36:39], v[40:43], 0
    v_mfma_f32_16x16x32_bf16 v[68:71], v[36:39], v[44:47], 0
    v_mfma_f32_16x16x32_bf16 v[76:79], v[36:39], v[48:51], 0
    v_cvt_pk_bf16_f32 v80, v200, v201
    v_lshlrev_b32 v81, 16, v80
    v_and_b32 v80, 0xffff0000, v80
    v_mul_f32 v82, 0x3fb8aa3b, v81
    v_mul_f32 v83, 0x3fb8aa3b, v80
    v_min_f32 v82, 0, v82
    v_min_f32 v83, 0, v83
    v_exp_f32 v82, v82
    v_exp_f32 v83, v83
    v_max_f32 v81, 0, v81
    v_max_f32 v80, 0, v80
    v_add_f32 v82, v82, v81
    v_add_f32 v83, v83, v80
    v_cvt_pk_bf16_f32 v80, v82, v83
    v_lshlrev_b32 v81, 16, v80
    v_and_b32 v80, 0xffff0000, v80
    v_add_f32 v81, 0x358637bd, v81
    v_add_f32 v80, 0x358637bd, v80
    v_cvt_pk_bf16_f32 v32, v81, v80
    v_cvt_pk_bf16_f32 v80, v202, v203
    v_lshlrev_b32 v81, 16, v80
    v_and_b32 v80, 0xffff0000, v80
    v_mul_f32 v82, 0x3fb8aa3b, v81
    v_mul_f32 v83, 0x3fb8aa3b, v80
    v_min_f32 v82, 0, v82
    v_min_f32 v83, 0, v83
    v_exp_f32 v82, v82
    v_exp_f32 v83, v83
    v_max_f32 v81, 0, v81
    v_max_f32 v80, 0, v80
    v_add_f32 v82, v82, v81
    v_add_f32 v83, v83, v80
    v_cvt_pk_bf16_f32 v80, v82, v83
    v_lshlrev_b32 v81, 16, v80
    v_and_b32 v80, 0xffff0000, v80
    v_add_f32 v81, 0x358637bd, v81
    v_add_f32 v80, 0x358637bd, v80
    v_cvt_pk_bf16_f32 v33, v81, v80
    v_cvt_pk_bf16_f32 v80, v204, v205
    v_lshlrev_b32 v81, 16, v80
    v_and_b32 v80, 0xffff0000, v80
    v_mul_f32 v82, 0x3fb8aa3b, v81
    v_mul_f32 v83, 0x3fb8aa3b, v80
    v_min_f32 v82, 0, v82
    v_min_f32 v83, 0, v83
    v_exp_f32 v82, v82
    v_exp_f32 v83, v83
    v_max_f32 v81, 0, v81
    v_max_f32 v80, 0, v80
    v_add_f32 v82, v82, v81
    v_add_f32 v83, v83, v80
    v_cvt_pk_bf16_f32 v80, v82, v83
    v_lshlrev_b32 v81, 16, v80
    v_and_b32 v80, 0xffff0000, v80
    v_add_f32 v81, 0x358637bd, v81
    v_add_f32 v80, 0x358637bd, v80
    v_cvt_pk_bf16_f32 v34, v81, v80
    v_cvt_pk_bf16_f32 v80, v206, v207
    v_lshlrev_b32 v81, 16, v80
    v_and_b32 v80, 0xffff0000, v80
    v_mul_f32 v82, 0x3fb8aa3b, v81
    v_mul_f32 v83, 0x3fb8aa3b, v80
    v_min_f32 v82, 0, v82
    v_min_f32 v83, 0, v83
    v_exp_f32 v82, v82
    v_exp_f32 v83, v83
    v_max_f32 v81, 0, v81
    v_max_f32 v80, 0, v80
    v_add_f32 v82, v82, v81
    v_add_f32 v83, v83, v80
    v_cvt_pk_bf16_f32 v80, v82, v83
    v_lshlrev_b32 v81, 16, v80
    v_and_b32 v80, 0xffff0000, v80
    v_add_f32 v81, 0x358637bd, v81
    v_add_f32 v80, 0x358637bd, v80
    v_cvt_pk_bf16_f32 v35, v81, v80
    v_cvt_pk_bf16_f32 v80, v216, v217
    v_lshlrev_b32 v81, 16, v80
    v_and_b32 v80, 0xffff0000, v80
    v_mul_f32 v82, 0x3fb8aa3b, v81
    v_mul_f32 v83, 0x3fb8aa3b, v80
    v_min_f32 v82, 0, v82
    v_min_f32 v83, 0, v83
    v_exp_f32 v82, v82
    v_exp_f32 v83, v83
    v_max_f32 v81, 0, v81
    v_max_f32 v80, 0, v80
    v_add_f32 v82, v82, v81
    v_add_f32 v83, v83, v80
    v_cvt_pk_bf16_f32 v80, v82, v83
    v_lshlrev_b32 v81, 16, v80
    v_and_b32 v80, 0xffff0000, v80
    v_add_f32 v81, 0x358637bd, v81
    v_add_f32 v80, 0x358637bd, v80
    v_cvt_pk_bf16_f32 v36, v81, v80
    v_cvt_pk_bf16_f32 v80, v218, v219
    v_lshlrev_b32 v81, 16, v80
    v_and_b32 v80, 0xffff0000, v80
    v_mul_f32 v82, 0x3fb8aa3b, v81
    v_mul_f32 v83, 0x3fb8aa3b, v80
    v_min_f32 v82, 0, v82
    v_min_f32 v83, 0, v83
    v_exp_f32 v82, v82
    v_exp_f32 v83, v83
    v_max_f32 v81, 0, v81
    v_max_f32 v80, 0, v80
    v_add_f32 v82, v82, v81
    v_add_f32 v83, v83, v80
    v_cvt_pk_bf16_f32 v80, v82, v83
    v_lshlrev_b32 v81, 16, v80
    v_and_b32 v80, 0xffff0000, v80
    v_add_f32 v81, 0x358637bd, v81
    v_add_f32 v80, 0x358637bd, v80
    v_cvt_pk_bf16_f32 v37, v81, v80
    v_cvt_pk_bf16_f32 v80, v220, v221
    v_lshlrev_b32 v81, 16, v80
    v_and_b32 v80, 0xffff0000, v80
    v_mul_f32 v82, 0x3fb8aa3b, v81
    v_mul_f32 v83, 0x3fb8aa3b, v80
    v_min_f32 v82, 0, v82
    v_min_f32 v83, 0, v83
    v_exp_f32 v82, v82
    v_exp_f32 v83, v83
    v_max_f32 v81, 0, v81
    v_max_f32 v80, 0, v80
    v_add_f32 v82, v82, v81
    v_add_f32 v83, v83, v80
    v_cvt_pk_bf16_f32 v80, v82, v83
    v_lshlrev_b32 v81, 16, v80
    v_and_b32 v80, 0xffff0000, v80
    v_add_f32 v81, 0x358637bd, v81
    v_add_f32 v80, 0x358637bd, v80
    v_cvt_pk_bf16_f32 v38, v81, v80
    v_cvt_pk_bf16_f32 v80, v222, v223
    v_lshlrev_b32 v81, 16, v80
    v_and_b32 v80, 0xffff0000, v80
    v_mul_f32 v82, 0x3fb8aa3b, v81
    v_mul_f32 v83, 0x3fb8aa3b, v80
    v_min_f32 v82, 0, v82
    v_min_f32 v83, 0, v83
    v_exp_f32 v82, v82
    v_exp_f32 v83, v83
    v_max_f32 v81, 0, v81
    v_max_f32 v80, 0, v80
    v_add_f32 v82, v82, v81
    v_add_f32 v83, v83, v80
    v_cvt_pk_bf16_f32 v80, v82, v83
    v_lshlrev_b32 v81, 16, v80
    v_and_b32 v80, 0xffff0000, v80
    v_add_f32 v81, 0x358637bd, v81
    v_add_f32 v80, 0x358637bd, v80
    v_cvt_pk_bf16_f32 v39, v81, v80
    v_cvt_pk_bf16_f32 v40, v232, v233
    v_cvt_pk_bf16_f32 v41, v234, v235
    v_cvt_pk_bf16_f32 v42, v236, v237
    v_cvt_pk_bf16_f32 v43, v238, v239
    v_cvt_pk_bf16_f32 v44, v248, v249
    v_cvt_pk_bf16_f32 v45, v250, v251
    v_cvt_pk_bf16_f32 v46, v252, v253
    v_cvt_pk_bf16_f32 v47, v254, v255
    s_nop 1
    v_mfma_f32_16x16x32_bf16 v[56:59], v[32:35], v[40:43], v[56:59]
    v_mfma_f32_16x16x32_bf16 v[60:63], v[32:35], v[44:47], v[60:63]
    v_mfma_f32_16x16x32_bf16 v[72:75], v[32:35], v[48:51], v[72:75]
    v_mfma_f32_16x16x32_bf16 v[64:67], v[36:39], v[40:43], v[64:67]
    v_mfma_f32_16x16x32_bf16 v[68:71], v[36:39], v[44:47], v[68:71]
    v_mfma_f32_16x16x32_bf16 v[76:79], v[36:39], v[48:51], v[76:79]
    s_nop 7
    s_mul_i32 s82, s33, 6144
    v_lshlrev_b32 v22, 3, v1
    v_add_u32 v23, s82, v22
    ds_write_b64 v23, v[56:57] offset:0
    ds_write_b64 v23, v[58:59] offset:512
    ds_write_b64 v23, v[60:61] offset:1024
    ds_write_b64 v23, v[62:63] offset:1536
    ds_write_b64 v23, v[64:65] offset:2048
    ds_write_b64 v23, v[66:67] offset:2560
    ds_write_b64 v23, v[68:69] offset:3072
    ds_write_b64 v23, v[70:71] offset:3584
    ds_write_b64 v23, v[72:73] offset:4096
    ds_write_b64 v23, v[74:75] offset:4608
    ds_write_b64 v23, v[76:77] offset:5120
    ds_write_b64 v23, v[78:79] offset:5632
    s_waitcnt lgkmcnt(0)
    s_barrier
    s_mul_i32 s82, s33, 1536
    v_add_u32 v23, s82, v22
    ds_read_b64 v[32:33], v23 offset:0
    ds_read_b64 v[34:35], v23 offset:6144
    ds_read_b64 v[36:37], v23 offset:12288
    ds_read_b64 v[38:39], v23 offset:18432
    ds_read_b64 v[40:41], v23 offset:512
    ds_read_b64 v[42:43], v23 offset:6656
    ds_read_b64 v[44:45], v23 offset:12800
    ds_read_b64 v[46:47], v23 offset:18944
    ds_read_b64 v[48:49], v23 offset:1024
    ds_read_b64 v[50:51], v23 offset:7168
    ds_read_b64 v[52:53], v23 offset:13312
    ds_read_b64 v[54:55], v23 offset:19456
    s_lshl_b32 s82, s31, 3
    s_add_u32 s82, s82, s30
    s_mul_i32 s82, s82, 6144
    s_add_u32 s82, s82, 18874368
    s_waitcnt lgkmcnt(0)
    v_add_f32 v32, v32, v34
    v_add_f32 v33, v33, v35
    v_add_f32 v36, v36, v38
    v_add_f32 v37, v37, v39
    v_add_f32 v32, v32, v36
    v_add_f32 v33, v33, v37
    buffer_store_dwordx2 v[32:33], v23, s[8:11], s82 offen offset:0 sc1
    v_add_f32 v40, v40, v42
    v_add_f32 v41, v41, v43
    v_add_f32 v44, v44, v46
    v_add_f32 v45, v45, v47
    v_add_f32 v40, v40, v44
    v_add_f32 v41, v41, v45
    buffer_store_dwordx2 v[40:41], v23, s[8:11], s82 offen offset:512 sc1
    v_add_f32 v48, v48, v50
    v_add_f32 v49, v49, v51
    v_add_f32 v52, v52, v54
    v_add_f32 v53, v53, v55
    v_add_f32 v48, v48, v52
    v_add_f32 v49, v49, v53
    buffer_store_dwordx2 v[48:49], v23, s[8:11], s82 offen offset:1024 sc1
    s_waitcnt vmcnt(0)
    s_barrier
    s_lshl_b32 s52, s31, 2
    v_mov_b32 v24, 1
    v_mov_b32 v25, 0
    s_cmp_lg_u32 s33, 0
    s_cbranch_scc1 nosig_18
    s_mov_b64 s[54:55], exec
    s_mov_b64 exec, 1
    buffer_atomic_add v24, v25, s[40:43], s52 offen sc1
    s_mov_b64 exec, s[54:55]
nosig_18:
    s_add_u32 s56, s48, 0
    v_cvt_pk_bf16_f32 v24, v96, v97
    v_cvt_pk_bf16_f32 v25, v98, v99
    v_cvt_pk_bf16_f32 v26, v128, v129
    v_cvt_pk_bf16_f32 v27, v130, v131
    v_lshlrev_b32 v28, 16, v24
    v_lshlrev_b32 v29, 16, v26
    v_and_b32 v24, 0xffff0000, v24
    v_and_b32 v26, 0xffff0000, v26
    v_mul_f32 v28, v28, v29
    v_mul_f32 v24, v24, v26
    v_lshlrev_b32 v29, 16, v25
    v_lshlrev_b32 v26, 16, v27
    v_and_b32 v25, 0xffff0000, v25
    v_and_b32 v27, 0xffff0000, v27
    v_mul_f32 v29, v29, v26
    v_mul_f32 v25, v25, v27
    v_cvt_pk_bf16_f32 v32, v28, v24
    v_cvt_pk_bf16_f32 v33, v29, v25
    v_cvt_pk_bf16_f32 v24, v112, v113
    v_cvt_pk_bf16_f32 v25, v114, v115
    v_cvt_pk_bf16_f32 v26, v144, v145
    v_cvt_pk_bf16_f32 v27, v146, v147
    v_lshlrev_b32 v28, 16, v24
    v_lshlrev_b32 v29, 16, v26
    v_and_b32 v24, 0xffff0000, v24
    v_and_b32 v26, 0xffff0000, v26
    v_mul_f32 v28, v28, v29
    v_mul_f32 v24, v24, v26
    v_lshlrev_b32 v29, 16, v25
    v_lshlrev_b32 v26, 16, v27
    v_and_b32 v25, 0xffff0000, v25
    v_and_b32 v27, 0xffff0000, v27
    v_mul_f32 v29, v29, v26
    v_mul_f32 v25, v25, v27
    v_cvt_pk_bf16_f32 v34, v28, v24
    v_cvt_pk_bf16_f32 v35, v29, v25
    s_nop 1
    v_permlane16_swap_b32 v32, v34
    v_permlane16_swap_b32 v33, v35
    buffer_store_dwordx4 v[32:35], v19, s[8:11], s56 offen offset:160
    s_add_u32 s56, s48, 147456
    v_cvt_pk_bf16_f32 v24, v100, v101
    v_cvt_pk_bf16_f32 v25, v102, v103
    v_cvt_pk_bf16_f32 v26, v132, v133
    v_cvt_pk_bf16_f32 v27, v134, v135
    v_lshlrev_b32 v28, 16, v24
    v_lshlrev_b32 v29, 16, v26
    v_and_b32 v24, 0xffff0000, v24
    v_and_b32 v26, 0xffff0000, v26
    v_mul_f32 v28, v28, v29
    v_mul_f32 v24, v24, v26
    v_lshlrev_b32 v29, 16, v25
    v_lshlrev_b32 v26, 16, v27
    v_and_b32 v25, 0xffff0000, v25
    v_and_b32 v27, 0xffff0000, v27
    v_mul_f32 v29, v29, v26
    v_mul_f32 v25, v25, v27
    v_cvt_pk_bf16_f32 v36, v28, v24
    v_cvt_pk_bf16_f32 v37, v29, v25
    v_cvt_pk_bf16_f32 v24, v116, v117
    v_cvt_pk_bf16_f32 v25, v118, v119
    v_cvt_pk_bf16_f32 v26, v148, v149
    v_cvt_pk_bf16_f32 v27, v150, v151
    v_lshlrev_b32 v28, 16, v24
    v_lshlrev_b32 v29, 16, v26
    v_and_b32 v24, 0xffff0000, v24
    v_and_b32 v26, 0xffff0000, v26
    v_mul_f32 v28, v28, v29
    v_mul_f32 v24, v24, v26
    v_lshlrev_b32 v29, 16, v25
    v_lshlrev_b32 v26, 16, v27
    v_and_b32 v25, 0xffff0000, v25
    v_and_b32 v27, 0xffff0000, v27
    v_mul_f32 v29, v29, v26
    v_mul_f32 v25, v25, v27
    v_cvt_pk_bf16_f32 v38, v28, v24
    v_cvt_pk_bf16_f32 v39, v29, v25
    s_nop 1
    v_permlane16_swap_b32 v36, v38
    v_permlane16_swap_b32 v37, v39
    buffer_store_dwordx4 v[36:39], v19, s[8:11], s56 offen offset:160
    s_add_u32 s56, s48, 294912
    v_cvt_pk_bf16_f32 v24, v104, v105
    v_cvt_pk_bf16_f32 v25, v106, v107
    v_cvt_pk_bf16_f32 v26, v136, v137
    v_cvt_pk_bf16_f32 v27, v138, v139
    v_lshlrev_b32 v28, 16, v24
    v_lshlrev_b32 v29, 16, v26
    v_and_b32 v24, 0xffff0000, v24
    v_and_b32 v26, 0xffff0000, v26
    v_mul_f32 v28, v28, v29
    v_mul_f32 v24, v24, v26
    v_lshlrev_b32 v29, 16, v25
    v_lshlrev_b32 v26, 16, v27
    v_and_b32 v25, 0xffff0000, v25
    v_and_b32 v27, 0xffff0000, v27
    v_mul_f32 v29, v29, v26
    v_mul_f32 v25, v25, v27
    v_cvt_pk_bf16_f32 v40, v28, v24
    v_cvt_pk_bf16_f32 v41, v29, v25
    v_cvt_pk_bf16_f32 v24, v120, v121
    v_cvt_pk_bf16_f32 v25, v122, v123
    v_cvt_pk_bf16_f32 v26, v152, v153
    v_cvt_pk_bf16_f32 v27, v154, v155
    v_lshlrev_b32 v28, 16, v24
    v_lshlrev_b32 v29, 16, v26
    v_and_b32 v24, 0xffff0000, v24
    v_and_b32 v26, 0xffff0000, v26
    v_mul_f32 v28, v28, v29
    v_mul_f32 v24, v24, v26
    v_lshlrev_b32 v29, 16, v25
    v_lshlrev_b32 v26, 16, v27
    v_and_b32 v25, 0xffff0000, v25
    v_and_b32 v27, 0xffff0000, v27
    v_mul_f32 v29, v29, v26
    v_mul_f32 v25, v25, v27
    v_cvt_pk_bf16_f32 v42, v28, v24
    v_cvt_pk_bf16_f32 v43, v29, v25
    s_nop 1
    v_permlane16_swap_b32 v40, v42
    v_permlane16_swap_b32 v41, v43
    buffer_store_dwordx4 v[40:43], v19, s[8:11], s56 offen offset:160
    s_add_u32 s56, s48, 442368
    v_cvt_pk_bf16_f32 v24, v108, v109
    v_cvt_pk_bf16_f32 v25, v110, v111
    v_cvt_pk_bf16_f32 v26, v140, v141
    v_cvt_pk_bf16_f32 v27, v142, v143
    v_lshlrev_b32 v28, 16, v24
    v_lshlrev_b32 v29, 16, v26
    v_and_b32 v24, 0xffff0000, v24
    v_and_b32 v26, 0xffff0000, v26
    v_mul_f32 v28, v28, v29
    v_mul_f32 v24, v24, v26
    v_lshlrev_b32 v29, 16, v25
    v_lshlrev_b32 v26, 16, v27
    v_and_b32 v25, 0xffff0000, v25
    v_and_b32 v27, 0xffff0000, v27
    v_mul_f32 v29, v29, v26
    v_mul_f32 v25, v25, v27
    v_cvt_pk_bf16_f32 v44, v28, v24
    v_cvt_pk_bf16_f32 v45, v29, v25
    v_cvt_pk_bf16_f32 v24, v124, v125
    v_cvt_pk_bf16_f32 v25, v126, v127
    v_cvt_pk_bf16_f32 v26, v156, v157
    v_cvt_pk_bf16_f32 v27, v158, v159
    v_lshlrev_b32 v28, 16, v24
    v_lshlrev_b32 v29, 16, v26
    v_and_b32 v24, 0xffff0000, v24
    v_and_b32 v26, 0xffff0000, v26
    v_mul_f32 v28, v28, v29
    v_mul_f32 v24, v24, v26
    v_lshlrev_b32 v29, 16, v25
    v_lshlrev_b32 v26, 16, v27
    v_and_b32 v25, 0xffff0000, v25
    v_and_b32 v27, 0xffff0000, v27
    v_mul_f32 v29, v29, v26
    v_mul_f32 v25, v25, v27
    v_cvt_pk_bf16_f32 v46, v28, v24
    v_cvt_pk_bf16_f32 v47, v29, v25
    s_nop 1
    v_permlane16_swap_b32 v44, v46
    v_permlane16_swap_b32 v45, v47
    buffer_store_dwordx4 v[44:47], v19, s[8:11], s56 offen offset:160
    v_cvt_pk_bf16_f32 v80, v160, v161
    v_lshlrev_b32 v81, 16, v80
    v_and_b32 v80, 0xffff0000, v80
    v_mul_f32 v82, 0x3fb8aa3b, v81
    v_mul_f32 v83, 0x3fb8aa3b, v80
    v_min_f32 v82, 0, v82
    v_min_f32 v83, 0, v83
    v_exp_f32 v82, v82
    v_exp_f32 v83, v83
    v_max_f32 v81, 0, v81
    v_max_f32 v80, 0, v80
    v_add_f32 v82, v82, v81
    v_add_f32 v83, v83, v80
    v_cvt_pk_bf16_f32 v80, v82, v83
    v_lshlrev_b32 v81, 16, v80
    v_and_b32 v80, 0xffff0000, v80
    v_add_f32 v81, 0x358637bd, v81
    v_add_f32 v80, 0x358637bd, v80
    v_cvt_pk_bf16_f32 v32, v81, v80
    v_cvt_pk_bf16_f32 v80, v162, v163
    v_lshlrev_b32 v81, 16, v80
    v_and_b32 v80, 0xffff0000, v80
    v_mul_f32 v82, 0x3fb8aa3b, v81
    v_mul_f32 v83, 0x3fb8aa3b, v80
    v_min_f32 v82, 0, v82
    v_min_f32 v83, 0, v83
    v_exp_f32 v82, v82
    v_exp_f32 v83, v83
    v_max_f32 v81, 0, v81
    v_max_f32 v80, 0, v80
    v_add_f32 v82, v82, v81
    v_add_f32 v83, v83, v80
    v_cvt_pk_bf16_f32 v80, v82, v83
    v_lshlrev_b32 v81, 16, v80
    v_and_b32 v80, 0xffff0000, v80
    v_add_f32 v81, 0x358637bd, v81
    v_add_f32 v80, 0x358637bd, v80
    v_cvt_pk_bf16_f32 v33, v81, v80
    v_cvt_pk_bf16_f32 v80, v176, v177
    v_lshlrev_b32 v81, 16, v80
    v_and_b32 v80, 0xffff0000, v80
    v_mul_f32 v82, 0x3fb8aa3b, v81
    v_mul_f32 v83, 0x3fb8aa3b, v80
    v_min_f32 v82, 0, v82
    v_min_f32 v83, 0, v83
    v_exp_f32 v82, v82
    v_exp_f32 v83, v83
    v_max_f32 v81, 0, v81
    v_max_f32 v80, 0, v80
    v_add_f32 v82, v82, v81
    v_add_f32 v83, v83, v80
    v_cvt_pk_bf16_f32 v80, v82, v83
    v_lshlrev_b32 v81, 16, v80
    v_and_b32 v80, 0xffff0000, v80
    v_add_f32 v81, 0x358637bd, v81
    v_add_f32 v80, 0x358637bd, v80
    v_cvt_pk_bf16_f32 v34, v81, v80
    v_cvt_pk_bf16_f32 v80, v178, v179
    v_lshlrev_b32 v81, 16, v80
    v_and_b32 v80, 0xffff0000, v80
    v_mul_f32 v82, 0x3fb8aa3b, v81
    v_mul_f32 v83, 0x3fb8aa3b, v80
    v_min_f32 v82, 0, v82
    v_min_f32 v83, 0, v83
    v_exp_f32 v82, v82
    v_exp_f32 v83, v83
    v_max_f32 v81, 0, v81
    v_max_f32 v80, 0, v80
    v_add_f32 v82, v82, v81
    v_add_f32 v83, v83, v80
    v_cvt_pk_bf16_f32 v80, v82, v83
    v_lshlrev_b32 v81, 16, v80
    v_and_b32 v80, 0xffff0000, v80
    v_add_f32 v81, 0x358637bd, v81
    v_add_f32 v80, 0x358637bd, v80
    v_cvt_pk_bf16_f32 v35, v81, v80
    v_cvt_pk_bf16_f32 v80, v164, v165
    v_lshlrev_b32 v81, 16, v80
    v_and_b32 v80, 0xffff0000, v80
    v_mul_f32 v82, 0x3fb8aa3b, v81
    v_mul_f32 v83, 0x3fb8aa3b, v80
    v_min_f32 v82, 0, v82
    v_min_f32 v83, 0, v83
    v_exp_f32 v82, v82
    v_exp_f32 v83, v83
    v_max_f32 v81, 0, v81
    v_max_f32 v80, 0, v80
    v_add_f32 v82, v82, v81
    v_add_f32 v83, v83, v80
    v_cvt_pk_bf16_f32 v80, v82, v83
    v_lshlrev_b32 v81, 16, v80
    v_and_b32 v80, 0xffff0000, v80
    v_add_f32 v81, 0x358637bd, v81
    v_add_f32 v80, 0x358637bd, v80
    v_cvt_pk_bf16_f32 v36, v81, v80
    v_cvt_pk_bf16_f32 v80, v166, v167
    v_lshlrev_b32 v81, 16, v80
    v_and_b32 v80, 0xffff0000, v80
    v_mul_f32 v82, 0x3fb8aa3b, v81
    v_mul_f32 v83, 0x3fb8aa3b, v80
    v_min_f32 v82, 0, v82
    v_min_f32 v83, 0, v83
    v_exp_f32 v82, v82
    v_exp_f32 v83, v83
    v_max_f32 v81, 0, v81
    v_max_f32 v80, 0, v80
    v_add_f32 v82, v82, v81
    v_add_f32 v83, v83, v80
    v_cvt_pk_bf16_f32 v80, v82, v83
    v_lshlrev_b32 v81, 16, v80
    v_and_b32 v80, 0xffff0000, v80
    v_add_f32 v81, 0x358637bd, v81
    v_add_f32 v80, 0x358637bd, v80
    v_cvt_pk_bf16_f32 v37, v81, v80
    v_cvt_pk_bf16_f32 v80, v180, v181
    v_lshlrev_b32 v81, 16, v80
    v_and_b32 v80, 0xffff0000, v80
    v_mul_f32 v82, 0x3fb8aa3b, v81
    v_mul_f32 v83, 0x3fb8aa3b, v80
    v_min_f32 v82, 0, v82
    v_min_f32 v83, 0, v83
    v_exp_f32 v82, v82
    v_exp_f32 v83, v83
    v_max_f32 v81, 0, v81
    v_max_f32 v80, 0, v80
    v_add_f32 v82, v82, v81
    v_add_f32 v83, v83, v80
    v_cvt_pk_bf16_f32 v80, v82, v83
    v_lshlrev_b32 v81, 16, v80
    v_and_b32 v80, 0xffff0000, v80
    v_add_f32 v81, 0x358637bd, v81
    v_add_f32 v80, 0x358637bd, v80
    v_cvt_pk_bf16_f32 v38, v81, v80
    v_cvt_pk_bf16_f32 v80, v182, v183
    v_lshlrev_b32 v81, 16, v80
    v_and_b32 v80, 0xffff0000, v80
    v_mul_f32 v82, 0x3fb8aa3b, v81
    v_mul_f32 v83, 0x3fb8aa3b, v80
    v_min_f32 v82, 0, v82
    v_min_f32 v83, 0, v83
    v_exp_f32 v82, v82
    v_exp_f32 v83, v83
    v_max_f32 v81, 0, v81
    v_max_f32 v80, 0, v80
    v_add_f32 v82, v82, v81
    v_add_f32 v83, v83, v80
    v_cvt_pk_bf16_f32 v80, v82, v83
    v_lshlrev_b32 v81, 16, v80
    v_and_b32 v80, 0xffff0000, v80
    v_add_f32 v81, 0x358637bd, v81
    v_add_f32 v80, 0x358637bd, v80
    v_cvt_pk_bf16_f32 v39, v81, v80
    v_cvt_pk_bf16_f32 v80, v168, v169
    v_lshlrev_b32 v81, 16, v80
    v_and_b32 v80, 0xffff0000, v80
    v_mul_f32 v82, 0x3fb8aa3b, v81
    v_mul_f32 v83, 0x3fb8aa3b, v80
    v_min_f32 v82, 0, v82
    v_min_f32 v83, 0, v83
    v_exp_f32 v82, v82
    v_exp_f32 v83, v83
    v_max_f32 v81, 0, v81
    v_max_f32 v80, 0, v80
    v_add_f32 v82, v82, v81
    v_add_f32 v83, v83, v80
    v_cvt_pk_bf16_f32 v80, v82, v83
    v_lshlrev_b32 v81, 16, v80
    v_and_b32 v80, 0xffff0000, v80
    v_add_f32 v81, 0x358637bd, v81
    v_add_f32 v80, 0x358637bd, v80
    v_cvt_pk_bf16_f32 v40, v81, v80
    v_cvt_pk_bf16_f32 v80, v170, v171
    v_lshlrev_b32 v81, 16, v80
    v_and_b32 v80, 0xffff0000, v80
    v_mul_f32 v82, 0x3fb8aa3b, v81
    v_mul_f32 v83, 0x3fb8aa3b, v80
    v_min_f32 v82, 0, v82
    v_min_f32 v83, 0, v83
    v_exp_f32 v82, v82
    v_exp_f32 v83, v83
    v_max_f32 v81, 0, v81
    v_max_f32 v80, 0, v80
    v_add_f32 v82, v82, v81
    v_add_f32 v83, v83, v80
    v_cvt_pk_bf16_f32 v80, v82, v83
    v_lshlrev_b32 v81, 16, v80
    v_and_b32 v80, 0xffff0000, v80
    v_add_f32 v81, 0x358637bd, v81
    v_add_f32 v80, 0x358637bd, v80
    v_cvt_pk_bf16_f32 v41, v81, v80
    v_cvt_pk_bf16_f32 v80, v184, v185
    v_lshlrev_b32 v81, 16, v80
    v_and_b32 v80, 0xffff0000, v80
    v_mul_f32 v82, 0x3fb8aa3b, v81
    v_mul_f32 v83, 0x3fb8aa3b, v80
    v_min_f32 v82, 0, v82
    v_min_f32 v83, 0, v83
    v_exp_f32 v82, v82
    v_exp_f32 v83, v83
    v_max_f32 v81, 0, v81
    v_max_f32 v80, 0, v80
    v_add_f32 v82, v82, v81
    v_add_f32 v83, v83, v80
    v_cvt_pk_bf16_f32 v80, v82, v83
    v_lshlrev_b32 v81, 16, v80
    v_and_b32 v80, 0xffff0000, v80
    v_add_f32 v81, 0x358637bd, v81
    v_add_f32 v80, 0x358637bd, v80
    v_cvt_pk_bf16_f32 v42, v81, v80
    v_cvt_pk_bf16_f32 v80, v186, v187
    v_lshlrev_b32 v81, 16, v80
    v_and_b32 v80, 0xffff0000, v80
    v_mul_f32 v82, 0x3fb8aa3b, v81
    v_mul_f32 v83, 0x3fb8aa3b, v80
    v_min_f32 v82, 0, v82
    v_min_f32 v83, 0, v83
    v_exp_f32 v82, v82
    v_exp_f32 v83, v83
    v_max_f32 v81, 0, v81
    v_max_f32 v80, 0, v80
    v_add_f32 v82, v82, v81
    v_add_f32 v83, v83, v80
    v_cvt_pk_bf16_f32 v80, v82, v83
    v_lshlrev_b32 v81, 16, v80
    v_and_b32 v80, 0xffff0000, v80
    v_add_f32 v81, 0x358637bd, v81
    v_add_f32 v80, 0x358637bd, v80
    v_cvt_pk_bf16_f32 v43, v81, v80
    v_cvt_pk_bf16_f32 v80, v172, v173
    v_lshlrev_b32 v81, 16, v80
    v_and_b32 v80, 0xffff0000, v80
    v_mul_f32 v82, 0x3fb8aa3b, v81
    v_mul_f32 v83, 0x3fb8aa3b, v80
    v_min_f32 v82, 0, v82
    v_min_f32 v83, 0, v83
    v_exp_f32 v82, v82
    v_exp_f32 v83, v83
    v_max_f32 v81, 0, v81
    v_max_f32 v80, 0, v80
    v_add_f32 v82, v82, v81
    v_add_f32 v83, v83, v80
    v_cvt_pk_bf16_f32 v80, v82, v83
    v_lshlrev_b32 v81, 16, v80
    v_and_b32 v80, 0xffff0000, v80
    v_add_f32 v81, 0x358637bd, v81
    v_add_f32 v80, 0x358637bd, v80
    v_cvt_pk_bf16_f32 v44, v81, v80
    v_cvt_pk_bf16_f32 v80, v174, v175
    v_lshlrev_b32 v81, 16, v80
    v_and_b32 v80, 0xffff0000, v80
    v_mul_f32 v82, 0x3fb8aa3b, v81
    v_mul_f32 v83, 0x3fb8aa3b, v80
    v_min_f32 v82, 0, v82
    v_min_f32 v83, 0, v83
    v_exp_f32 v82, v82
    v_exp_f32 v83, v83
    v_max_f32 v81, 0, v81
    v_max_f32 v80, 0, v80
    v_add_f32 v82, v82, v81
    v_add_f32 v83, v83, v80
    v_cvt_pk_bf16_f32 v80, v82, v83
    v_lshlrev_b32 v81, 16, v80
    v_and_b32 v80, 0xffff0000, v80
    v_add_f32 v81, 0x358637bd, v81
    v_add_f32 v80, 0x358637bd, v80
    v_cvt_pk_bf16_f32 v45, v81, v80
    v_cvt_pk_bf16_f32 v80, v188, v189
    v_lshlrev_b32 v81, 16, v80
    v_and_b32 v80, 0xffff0000, v80
    v_mul_f32 v82, 0x3fb8aa3b, v81
    v_mul_f32 v83, 0x3fb8aa3b, v80
    v_min_f32 v82, 0, v82
    v_min_f32 v83, 0, v83
    v_exp_f32 v82, v82
    v_exp_f32 v83, v83
    v_max_f32 v81, 0, v81
    v_max_f32 v80, 0, v80
    v_add_f32 v82, v82, v81
    v_add_f32 v83, v83, v80
    v_cvt_pk_bf16_f32 v80, v82, v83
    v_lshlrev_b32 v81, 16, v80
    v_and_b32 v80, 0xffff0000, v80
    v_add_f32 v81, 0x358637bd, v81
    v_add_f32 v80, 0x358637bd, v80
    v_cvt_pk_bf16_f32 v46, v81, v80
    v_cvt_pk_bf16_f32 v80, v190, v191
    v_lshlrev_b32 v81, 16, v80
    v_and_b32 v80, 0xffff0000, v80
    v_mul_f32 v82, 0x3fb8aa3b, v81
    v_mul_f32 v83, 0x3fb8aa3b, v80
    v_min_f32 v82, 0, v82
    v_min_f32 v83, 0, v83
    v_exp_f32 v82, v82
    v_exp_f32 v83, v83
    v_max_f32 v81, 0, v81
    v_max_f32 v80, 0, v80
    v_add_f32 v82, v82, v81
    v_add_f32 v83, v83, v80
    v_cvt_pk_bf16_f32 v80, v82, v83
    v_lshlrev_b32 v81, 16, v80
    v_and_b32 v80, 0xffff0000, v80
    v_add_f32 v81, 0x358637bd, v81
    v_add_f32 v80, 0x358637bd, v80
    v_cvt_pk_bf16_f32 v47, v81, v80
    v_mov_b32 v25, 0
poll_19:
    buffer_load_dword v24, v25, s[40:43], s52 offen sc1
    s_waitcnt vmcnt(0)
    v_readfirstlane_b32 s82, v24
    s_cmp_ge_u32 s82, 8
    s_cbranch_scc1 poll_19_ok
    s_sleep 2
    s_branch poll_19
poll_19_ok:
    s_lshl_b32 s82, s31, 3
    s_mul_i32 s82, s82, 6144
    s_add_u32 s82, s82, 18874368
    buffer_load_dwordx2 v[96:97], v23, s[8:11], s82 offen offset:0 sc1
    buffer_load_dwordx2 v[112:113], v23, s[8:11], s82 offen offset:512 sc1
    buffer_load_dwordx2 v[128:129], v23, s[8:11], s82 offen offset:1024 sc1
    s_add_u32 s82, s82, 6144
    buffer_load_dwordx2 v[98:99], v23, s[8:11], s82 offen offset:0 sc1
    buffer_load_dwordx2 v[114:115], v23, s[8:11], s82 offen offset:512 sc1
    buffer_load_dwordx2 v[130:131], v23, s[8:11], s82 offen offset:1024 sc1
    s_add_u32 s82, s82, 6144
    buffer_load_dwordx2 v[100:101], v23, s[8:11], s82 offen offset:0 sc1
    buffer_load_dwordx2 v[116:117], v23, s[8:11], s82 offen offset:512 sc1
    buffer_load_dwordx2 v[132:133], v23, s[8:11], s82 offen offset:1024 sc1
    s_add_u32 s82, s82, 6144
    buffer_load_dwordx2 v[102:103], v23, s[8:11], s82 offen offset:0 sc1
    buffer_load_dwordx2 v[118:119], v23, s[8:11], s82 offen offset:512 sc1
    buffer_load_dwordx2 v[134:135], v23, s[8:11], s82 offen offset:1024 sc1
    s_add_u32 s82, s82, 6144
    buffer_load_dwordx2 v[104:105], v23, s[8:11], s82 offen offset:0 sc1
    buffer_load_dwordx2 v[120:121], v23, s[8:11], s82 offen offset:512 sc1
    buffer_load_dwordx2 v[136:137], v23, s[8:11], s82 offen offset:1024 sc1
    s_add_u32 s82, s82, 6144
    buffer_load_dwordx2 v[106:107], v23, s[8:11], s82 offen offset:0 sc1
    buffer_load_dwordx2 v[122:123], v23, s[8:11], s82 offen offset:512 sc1
    buffer_load_dwordx2 v[138:139], v23, s[8:11], s82 offen offset:1024 sc1
    s_add_u32 s82, s82, 6144
    buffer_load_dwordx2 v[108:109], v23, s[8:11], s82 offen offset:0 sc1
    buffer_load_dwordx2 v[124:125], v23, s[8:11], s82 offen offset:512 sc1
    buffer_load_dwordx2 v[140:141], v23, s[8:11], s82 offen offset:1024 sc1
    s_add_u32 s82, s82, 6144
    buffer_load_dwordx2 v[110:111], v23, s[8:11], s82 offen offset:0 sc1
    buffer_load_dwordx2 v[126:127], v23, s[8:11], s82 offen offset:512 sc1
    buffer_load_dwordx2 v[142:143], v23, s[8:11], s82 offen offset:1024 sc1
    s_waitcnt vmcnt(0)
    v_add_f32 v96, v96, v104
    v_add_f32 v97, v97, v105
    v_add_f32 v98, v98, v106
    v_add_f32 v99, v99, v107
    v_add_f32 v100, v100, v108
    v_add_f32 v101, v101, v109
    v_add_f32 v102, v102, v110
    v_add_f32 v103, v103, v111
    v_add_f32 v96, v96, v100
    v_add_f32 v97, v97, v101
    v_add_f32 v98, v98, v102
    v_add_f32 v99, v99, v103
    v_add_f32 v96, v96, v98
    v_add_f32 v97, v97, v99
    ds_write_b64 v23, v[96:97] offset:0
    v_add_f32 v112, v112, v120
    v_add_f32 v113, v113, v121
    v_add_f32 v114, v114, v122
    v_add_f32 v115, v115, v123
    v_add_f32 v116, v116, v124
    v_add_f32 v117, v117, v125
    v_add_f32 v118, v118, v126
    v_add_f32 v119, v119, v127
    v_add_f32 v112, v112, v116
    v_add_f32 v113, v113, v117
    v_add_f32 v114, v114, v118
    v_add_f32 v115, v115, v119
    v_add_f32 v112, v112, v114
    v_add_f32 v113, v113, v115
    ds_write_b64 v23, v[112:113] offset:512
    v_add_f32 v128, v128, v136
    v_add_f32 v129, v129, v137
    v_add_f32 v130, v130, v138
    v_add_f32 v131, v131, v139
    v_add_f32 v132, v132, v140
    v_add_f32 v133, v133, v141
    v_add_f32 v134, v134, v142
    v_add_f32 v135, v135, v143
    v_add_f32 v128, v128, v132
    v_add_f32 v129, v129, v133
    v_add_f32 v130, v130, v134
    v_add_f32 v131, v131, v135
    v_add_f32 v128, v128, v130
    v_add_f32 v129, v129, v131
    ds_write_b64 v23, v[128:129] offset:1024
    s_waitcnt lgkmcnt(0)
    s_barrier
    ds_read_b64 v[56:57], v22 offset:0
    ds_read_b64 v[58:59], v22 offset:512
    ds_read_b64 v[60:61], v22 offset:1024
    ds_read_b64 v[62:63], v22 offset:1536
    ds_read_b64 v[64:65], v22 offset:2048
    ds_read_b64 v[66:67], v22 offset:2560
    ds_read_b64 v[68:69], v22 offset:3072
    ds_read_b64 v[70:71], v22 offset:3584
    ds_read_b64 v[72:73], v22 offset:4096
    ds_read_b64 v[74:75], v22 offset:4608
    ds_read_b64 v[76:77], v22 offset:5120
    ds_read_b64 v[78:79], v22 offset:5632
    s_waitcnt lgkmcnt(0)
    v_cvt_pk_bf16_f32 v96, v56, v57
    v_cvt_pk_bf16_f32 v97, v58, v59
    v_cvt_pk_bf16_f32 v98, v64, v65
    v_cvt_pk_bf16_f32 v99, v66, v67
    v_cvt_pk_bf16_f32 v100, v60, v61
    v_cvt_pk_bf16_f32 v101, v62, v63
    v_cvt_pk_bf16_f32 v102, v68, v69
    v_cvt_pk_bf16_f32 v103, v70, v71
    v_cvt_pk_bf16_f32 v104, v72, v73
    v_cvt_pk_bf16_f32 v105, v74, v75
    v_cvt_pk_bf16_f32 v106, v76, v77
    v_cvt_pk_bf16_f32 v107, v78, v79
    s_add_u32 s48, s49, s36
    s_nop 0
    v_mfma_f32_16x16x32_bf16 v[112:115], v[96:99], v[32:35], 0
    v_mfma_f32_16x16x32_bf16 v[116:119], v[100:103], v[32:35], 0
    v_mfma_f32_16x16x32_bf16 v[120:123], v[104:107], v[32:35], 0
    v_mfma_f32_16x16x32_bf16 v[124:127], v[96:99], v[36:39], 0
    v_mfma_f32_16x16x32_bf16 v[128:131], v[100:103], v[36:39], 0
    v_mfma_f32_16x16x32_bf16 v[132:135], v[104:107], v[36:39], 0
    v_mfma_f32_16x16x32_bf16 v[136:139], v[96:99], v[40:43], 0
    v_mfma_f32_16x16x32_bf16 v[140:143], v[100:103], v[40:43], 0
    v_mfma_f32_16x16x32_bf16 v[144:147], v[104:107], v[40:43], 0
    v_mfma_f32_16x16x32_bf16 v[148:151], v[96:99], v[44:47], 0
    v_mfma_f32_16x16x32_bf16 v[152:155], v[100:103], v[44:47], 0
    v_mfma_f32_16x16x32_bf16 v[156:159], v[104:107], v[44:47], 0
    s_nop 7
    s_add_u32 s56, s48, 0
    v_cvt_pk_bf16_f32 v24, v120, v120
    v_lshlrev_b32 v24, 16, v24
    v_add_f32 v24, 0x358637bd, v24
    v_cvt_pk_bf16_f32 v24, v24, v24
    v_lshlrev_b32 v24, 16, v24
    v_rcp_f32 v24, v24
    v_cvt_pk_bf16_f32 v56, v112, v113
    v_cvt_pk_bf16_f32 v57, v114, v115
    v_lshlrev_b32 v58, 16, v56
    v_and_b32 v59, 0xffff0000, v56
    v_lshlrev_b32 v60, 16, v57
    v_and_b32 v61, 0xffff0000, v57
    v_mul_f32 v58, v58, v24
    v_mul_f32 v59, v59, v24
    v_mul_f32 v60, v60, v24
    v_mul_f32 v61, v61, v24
    v_cvt_pk_bf16_f32 v72, v58, v59
    v_cvt_pk_bf16_f32 v73, v60, v61
    v_cvt_pk_bf16_f32 v64, v116, v117
    v_cvt_pk_bf16_f32 v65, v118, v119
    v_lshlrev_b32 v66, 16, v64
    v_and_b32 v67, 0xffff0000, v64
    v_lshlrev_b32 v68, 16, v65
    v_and_b32 v69, 0xffff0000, v65
    v_mul_f32 v66, v66, v24
    v_mul_f32 v67, v67, v24
    v_mul_f32 v68, v68, v24
    v_mul_f32 v69, v69, v24
    v_cvt_pk_bf16_f32 v74, v66, v67
    v_cvt_pk_bf16_f32 v75, v68, v69
    s_nop 1
    v_permlane16_swap_b32 v72, v74
    v_permlane16_swap_b32 v73, v75
    buffer_store_dwordx4 v[72:75], v19, s[8:11], s56 offen
    s_add_u32 s56, s48, 147456
    v_cvt_pk_bf16_f32 v24, v132, v132
    v_lshlrev_b32 v24, 16, v24
    v_add_f32 v24, 0x358637bd, v24
    v_cvt_pk_bf16_f32 v24, v24, v24
    v_lshlrev_b32 v24, 16, v24
    v_rcp_f32 v24, v24
    v_cvt_pk_bf16_f32 v56, v124, v125
    v_cvt_pk_bf16_f32 v57, v126, v127
    v_lshlrev_b32 v58, 16, v56
    v_and_b32 v59, 0xffff0000, v56
    v_lshlrev_b32 v60, 16, v57
    v_and_b32 v61, 0xffff0000, v57
    v_mul_f32 v58, v58, v24
    v_mul_f32 v59, v59, v24
    v_mul_f32 v60, v60, v24
    v_mul_f32 v61, v61, v24
    v_cvt_pk_bf16_f32 v76, v58, v59
    v_cvt_pk_bf16_f32 v77, v60, v61
    v_cvt_pk_bf16_f32 v64, v128, v129
    v_cvt_pk_bf16_f32 v65, v130, v131
    v_lshlrev_b32 v66, 16, v64
    v_and_b32 v67, 0xffff0000, v64
    v_lshlrev_b32 v68, 16, v65
    v_and_b32 v69, 0xffff0000, v65
    v_mul_f32 v66, v66, v24
    v_mul_f32 v67, v67, v24
    v_mul_f32 v68, v68, v24
    v_mul_f32 v69, v69, v24
    v_cvt_pk_bf16_f32 v78, v66, v67
    v_cvt_pk_bf16_f32 v79, v68, v69
    s_nop 1
    v_permlane16_swap_b32 v76, v78
    v_permlane16_swap_b32 v77, v79
    buffer_store_dwordx4 v[76:79], v19, s[8:11], s56 offen
    s_add_u32 s56, s48, 294912
    v_cvt_pk_bf16_f32 v24, v144, v144
    v_lshlrev_b32 v24, 16, v24
    v_add_f32 v24, 0x358637bd, v24
    v_cvt_pk_bf16_f32 v24, v24, v24
    v_lshlrev_b32 v24, 16, v24
    v_rcp_f32 v24, v24
    v_cvt_pk_bf16_f32 v56, v136, v137
    v_cvt_pk_bf16_f32 v57, v138, v139
    v_lshlrev_b32 v58, 16, v56
    v_and_b32 v59, 0xffff0000, v56
    v_lshlrev_b32 v60, 16, v57
    v_and_b32 v61, 0xffff0000, v57
    v_mul_f32 v58, v58, v24
    v_mul_f32 v59, v59, v24
    v_mul_f32 v60, v60, v24
    v_mul_f32 v61, v61, v24
    v_cvt_pk_bf16_f32 v80, v58, v59
    v_cvt_pk_bf16_f32 v81, v60, v61
    v_cvt_pk_bf16_f32 v64, v140, v141
    v_cvt_pk_bf16_f32 v65, v142, v143
    v_lshlrev_b32 v66, 16, v64
    v_and_b32 v67, 0xffff0000, v64
    v_lshlrev_b32 v68, 16, v65
    v_and_b32 v69, 0xffff0000, v65
    v_mul_f32 v66, v66, v24
    v_mul_f32 v67, v67, v24
    v_mul_f32 v68, v68, v24
    v_mul_f32 v69, v69, v24
    v_cvt_pk_bf16_f32 v82, v66, v67
    v_cvt_pk_bf16_f32 v83, v68, v69
    s_nop 1
    v_permlane16_swap_b32 v80, v82
    v_permlane16_swap_b32 v81, v83
    buffer_store_dwordx4 v[80:83], v19, s[8:11], s56 offen
    s_add_u32 s56, s48, 442368
    v_cvt_pk_bf16_f32 v24, v156, v156
    v_lshlrev_b32 v24, 16, v24
    v_add_f32 v24, 0x358637bd, v24
    v_cvt_pk_bf16_f32 v24, v24, v24
    v_lshlrev_b32 v24, 16, v24
    v_rcp_f32 v24, v24
    v_cvt_pk_bf16_f32 v56, v148, v149
    v_cvt_pk_bf16_f32 v57, v150, v151
    v_lshlrev_b32 v58, 16, v56
    v_and_b32 v59, 0xffff0000, v56
    v_lshlrev_b32 v60, 16, v57
    v_and_b32 v61, 0xffff0000, v57
    v_mul_f32 v58, v58, v24
    v_mul_f32 v59, v59, v24
    v_mul_f32 v60, v60, v24
    v_mul_f32 v61, v61, v24
    v_cvt_pk_bf16_f32 v84, v58, v59
    v_cvt_pk_bf16_f32 v85, v60, v61
    v_cvt_pk_bf16_f32 v64, v152, v153
    v_cvt_pk_bf16_f32 v65, v154, v155
    v_lshlrev_b32 v66, 16, v64
    v_and_b32 v67, 0xffff0000, v64
    v_lshlrev_b32 v68, 16, v65
    v_and_b32 v69, 0xffff0000, v65
    v_mul_f32 v66, v66, v24
    v_mul_f32 v67, v67, v24
    v_mul_f32 v68, v68, v24
    v_mul_f32 v69, v69, v24
    v_cvt_pk_bf16_f32 v86, v66, v67
    v_cvt_pk_bf16_f32 v87, v68, v69
    s_nop 1
    v_permlane16_swap_b32 v84, v86
    v_permlane16_swap_b32 v85, v87
    buffer_store_dwordx4 v[84:87], v19, s[8:11], s56 offen
    s_waitcnt vmcnt(0)
k1_kernel_done:
    s_endpgm
    .globl k2_kernel
    .p2align 8
    .type k2_kernel,@function
k2_kernel:
    s_cmp_ge_u32 s2, 256
    s_cbranch_scc1 k2_kernel_done
    s_load_dwordx2 s[12:13], s[0:1], 16
    s_load_dwordx2 s[14:15], s[0:1], 48
    s_load_dwordx4 s[28:31], s[0:1], 64
    s_load_dwordx2 s[32:33], s[0:1], 80
    v_and_b32 v1, 63, v0
    v_lshrrev_b32 v2, 6, v0
    s_nop 0
    v_readfirstlane_b32 s40, v2
    s_and_b32 s58, s2, 7
    s_lshr_b32 s59, s2, 3
    s_lshr_b32 s38, s58, 1
    s_lshl_b32 s38, s38, 2
    s_and_b32 s60, s59, 3
    s_add_u32 s38, s38, s60
    s_and_b32 s39, s58, 1
    s_lshl_b32 s39, s39, 2
    s_lshr_b32 s60, s59, 2
    s_and_b32 s60, s60, 3
    s_add_u32 s39, s39, s60
    s_lshr_b32 s44, s59, 4
    s_xor_b32 s44, s44, 1
    s_lshr_b32 s41, s40, 1
    s_and_b32 s42, s40, 1
    v_lshrrev_b32 v2, 4, v1
    v_and_b32 v3, 3, v1
    v_lshrrev_b32 v4, 2, v1
    v_and_b32 v4, 3, v4
    v_and_b32 v5, 15, v1
    v_lshrrev_b32 v6, 3, v1
    v_and_b32 v7, 7, v1
    v_xor_b32 v7, v7, v2
    v_xor_b32 v28, 4, v7
    v_lshlrev_b32 v7, 4, v7
    v_lshlrev_b32 v28, 4, v28
    v_mul_u32_u24 v6, 9216, v6
    s_lshl_b32 s58, s38, 7
    s_lshl_b32 s59, s40, 5
    s_add_u32 s58, s58, s59
    s_mul_i32 s58, s58, 9216
    v_add_u32 v6, s58, v6
    v_add_u32 v8, v7, v6
    v_add_u32 v9, v28, v6
    v_add_u32 v9, 73728, v9
    v_add_u32 v10, 147456, v8
    v_add_u32 v11, 147456, v9
    s_lshl_b32 s50, s40, 12
    s_add_u32 s52, s50, 16384
    v_lshlrev_b32 v6, 1, v2
    v_xor_b32 v6, v6, v5
    v_xor_b32 v7, 8, v6
    v_lshlrev_b32 v6, 4, v6
    v_lshlrev_b32 v7, 4, v7
    v_lshlrev_b32 v28, 11, v2
    s_lshl_b32 s58, s40, 15
    s_lshl_b32 s59, s39, 8
    s_add_u32 s58, s58, s59
    v_add_u32 v28, s58, v28
    v_add_u32 v12, v6, v28
    v_add_u32 v13, 0x2000, v12
    v_add_u32 v14, v7, v28
    v_add_u32 v14, 0x4000, v14
    v_add_u32 v15, 0x2000, v14
    s_waitcnt lgkmcnt(0)
    s_mov_b32 s4, s32
    s_mov_b32 s5, s33
    s_mov_b32 s6, 18874368
    s_mov_b32 s7, 0x00020000
    s_cmp_eq_u32 s44, 0
    s_cselect_b32 s8, s12, s14
    s_cselect_b32 s9, s13, s15
    s_mov_b32 s61, 2097152
    s_mov_b32 s62, 7340032
    s_cselect_b32 s10, s61, s62
    s_mov_b32 s11, 0x00020000
    s_cselect_b32 s47, 0, 39
    s_cselect_b32 s45, 0, 4992
    s_cselect_b32 s46, 0, 3014656
    s_mov_b32 s55, 0
    s_mov_b32 s56, 0
    s_add_u32 m0, s55, s50
    s_nop 0
    s_nop 0
    buffer_load_dwordx4 v8, s[4:7], s45 offen lds
    s_add_u32 m0, s55, s50
    s_add_u32 m0, m0, 1024
    s_nop 0
    buffer_load_dwordx4 v9, s[4:7], s45 offen lds
    s_add_u32 m0, s55, s50
    s_add_u32 m0, m0, 2048
    s_nop 0
    buffer_load_dwordx4 v10, s[4:7], s45 offen lds
    s_add_u32 m0, s55, s50
    s_add_u32 m0, m0, 3072
    s_nop 0
    buffer_load_dwordx4 v11, s[4:7], s45 offen lds
    s_add_u32 m0, s55, s52
    s_nop 0
    s_nop 0
    buffer_load_dwordx4 v12, s[8:11], s46 offen lds
    s_add_u32 m0, s55, s52
    s_add_u32 m0, m0, 1024
    s_nop 0
    buffer_load_dwordx4 v13, s[8:11], s46 offen lds
    s_add_u32 m0, s55, s52
    s_add_u32 m0, m0, 2048
    s_nop 0
    buffer_load_dwordx4 v14, s[8:11], s46 offen lds
    s_add_u32 m0, s55, s52
    s_add_u32 m0, m0, 3072
    s_nop 0
    buffer_load_dwordx4 v15, s[8:11], s46 offen lds
    s_add_u32 s45, s45, 128
    s_add_u32 s46, s46, 131072
    s_add_u32 s47, s47, 1
    s_cmp_eq_u32 s47, 16
    s_cselect_b32 s8, s14, s8
    s_cselect_b32 s9, s15, s9
    s_cselect_b32 s10, s62, s10
    s_cselect_b32 s46, 0, s46
    s_add_u32 s55, s55, 32768
    s_cmp_eq_u32 s55, 131072
    s_cselect_b32 s55, 0, s55
    s_add_u32 m0, s55, s50
    s_nop 0
    s_nop 0
    buffer_load_dwordx4 v8, s[4:7], s45 offen lds
    s_add_u32 m0, s55, s50
    s_add_u32 m0, m0, 1024
    s_nop 0
    buffer_load_dwordx4 v9, s[4:7], s45 offen lds
    s_add_u32 m0, s55, s50
    s_add_u32 m0, m0, 2048
    s_nop 0
    buffer_load_dwordx4 v10, s[4:7], s45 offen lds
    s_add_u32 m0, s55, s50
    s_add_u32 m0, m0, 3072
    s_nop 0
    buffer_load_dwordx4 v11, s[4:7], s45 offen lds
    s_add_u32 m0, s55, s52
    s_nop 0
    s_nop 0
    buffer_load_dwordx4 v12, s[8:11], s46 offen lds
    s_add_u32 m0, s55, s52
    s_add_u32 m0, m0, 1024
    s_nop 0
    buffer_load_dwordx4 v13, s[8:11], s46 offen lds
    s_add_u32 m0, s55, s52
    s_add_u32 m0, m0, 2048
    s_nop 0
    buffer_load_dwordx4 v14, s[8:11], s46 offen lds
    s_add_u32 m0, s55, s52
    s_add_u32 m0, m0, 3072
    s_nop 0
    buffer_load_dwordx4 v15, s[8:11], s46 offen lds
    s_add_u32 s45, s45, 128
    s_add_u32 s46, s46, 131072
    s_add_u32 s47, s47, 1
    s_cmp_eq_u32 s47, 16
    s_cselect_b32 s8, s14, s8
    s_cselect_b32 s9, s15, s9
    s_cselect_b32 s10, s62, s10
    s_cselect_b32 s46, 0, s46
    s_add_u32 s55, s55, 32768
    s_cmp_eq_u32 s55, 131072
    s_cselect_b32 s55, 0, s55
    s_add_u32 m0, s55, s50
    s_nop 0
    s_nop 0
    buffer_load_dwordx4 v8, s[4:7], s45 offen lds
    s_add_u32 m0, s55, s50
    s_add_u32 m0, m0, 1024
    s_nop 0
    buffer_load_dwordx4 v9, s[4:7], s45 offen lds
    s_add_u32 m0, s55, s50
    s_add_u32 m0, m0, 2048
    s_nop 0
    buffer_load_dwordx4 v10, s[4:7], s45 offen lds
    s_add_u32 m0, s55, s50
    s_add_u32 m0, m0, 3072
    s_nop 0
    buffer_load_dwordx4 v11, s[4:7], s45 offen lds
    s_add_u32 m0, s55, s52
    s_nop 0
    s_nop 0
    buffer_load_dwordx4 v12, s[8:11], s46 offen lds
    s_add_u32 m0, s55, s52
    s_add_u32 m0, m0, 1024
    s_nop 0
    buffer_load_dwordx4 v13, s[8:11], s46 offen lds
    s_add_u32 m0, s55, s52
    s_add_u32 m0, m0, 2048
    s_nop 0
    buffer_load_dwordx4 v14, s[8:11], s46 offen lds
    s_add_u32 m0, s55, s52
    s_add_u32 m0, m0, 3072
    s_nop 0
    buffer_load_dwordx4 v15, s[8:11], s46 offen lds
    s_add_u32 s45, s45, 128
    s_add_u32 s46, s46, 131072
    s_add_u32 s47, s47, 1
    s_cmp_eq_u32 s47, 16
    s_cselect_b32 s8, s14, s8
    s_cselect_b32 s9, s15, s9
    s_cselect_b32 s10, s62, s10
    s_cselect_b32 s46, 0, s46
    s_add_u32 s55, s55, 32768
    s_cmp_eq_u32 s55, 131072
    s_cselect_b32 s55, 0, s55
    s_mov_b32 s16, s28
    s_mov_b32 s17, s29
    s_mov_b32 s18, 4194304
    s_mov_b32 s19, 0x00020000
    s_mov_b32 s20, s32
    s_mov_b32 s21, s33
    s_mov_b32 s22, 28844288
    s_mov_b32 s23, 0x00020000
    s_mov_b32 s24, s30
    s_mov_b32 s25, s31
    s_mov_b32 s26, 256
    s_mov_b32 s27, 0x00020000
    v_lshrrev_b32 v6, 1, v5
    v_xor_b32 v6, v6, v2
    v_xor_b32 v7, 4, v6
    v_lshlrev_b32 v6, 4, v6
    v_lshlrev_b32 v7, 4, v7
    v_lshlrev_b32 v16, 7, v5
    s_lshl_b32 s58, s41, 13
    v_add_u32 v16, s58, v16
    v_add_u32 v17, v16, v7
    v_add_u32 v16, v16, v6
    v_and_b32 v6, 1, v2
    v_lshlrev_b32 v6, 2, v6
    v_or_b32 v6, v6, v4
    v_lshlrev_b32 v7, 3, v2
    v_add_u32 v7, v7, v4
    v_lshlrev_b32 v7, 8, v7
    v_lshrrev_b32 v28, 1, v3
    v_lshlrev_b32 v28, 4, v28
    v_and_b32 v29, 1, v3
    v_lshlrev_b32 v29, 3, v29
    v_add_u32 v7, v7, v28
    v_add_u32 v7, v7, v29
    v_add_u32 v7, 0x4000, v7
    s_lshl_b32 s58, s42, 2
    s_add_u32 s59, s58, 0
    v_xor_b32 v28, s59, v6
    v_lshlrev_b32 v28, 5, v28
    v_add_u32 v20, v7, v28
    s_add_u32 s59, s58, 1
    v_xor_b32 v28, s59, v6
    v_lshlrev_b32 v28, 5, v28
    v_add_u32 v21, v7, v28
    s_add_u32 s59, s58, 2
    v_xor_b32 v28, s59, v6
    v_lshlrev_b32 v28, 5, v28
    v_add_u32 v22, v7, v28
    s_add_u32 s59, s58, 3
    v_xor_b32 v28, s59, v6
    v_lshlrev_b32 v28, 5, v28
    v_add_u32 v23, v7, v28
    v_mov_b32 v96, 0
    v_mov_b32 v97, 0
    v_mov_b32 v98, 0
    v_mov_b32 v99, 0
    v_mov_b32 v100, 0
    v_mov_b32 v101, 0
    v_mov_b32 v102, 0
    v_mov_b32 v103, 0
    v_mov_b32 v104, 0
    v_mov_b32 v105, 0
    v_mov_b32 v106, 0
    v_mov_b32 v107, 0
    v_mov_b32 v108, 0
    v_mov_b32 v109, 0
    v_mov_b32 v110, 0
    v_mov_b32 v111, 0
    v_mov_b32 v112, 0
    v_mov_b32 v113, 0
    v_mov_b32 v114, 0
    v_mov_b32 v115, 0
    v_mov_b32 v116, 0
    v_mov_b32 v117, 0
    v_mov_b32 v118, 0
    v_mov_b32 v119, 0
    v_mov_b32 v120, 0
    v_mov_b32 v121, 0
    v_mov_b32 v122, 0
    v_mov_b32 v123, 0
    v_mov_b32 v124, 0
    v_mov_b32 v125, 0
    v_mov_b32 v126, 0
    v_mov_b32 v127, 0
    v_mov_b32 v128, 0
    v_mov_b32 v129, 0
    v_mov_b32 v130, 0
    v_mov_b32 v131, 0
    v_mov_b32 v132, 0
    v_mov_b32 v133, 0
    v_mov_b32 v134, 0
    v_mov_b32 v135, 0
    v_mov_b32 v136, 0
    v_mov_b32 v137, 0
    v_mov_b32 v138, 0
    v_mov_b32 v139, 0
    v_mov_b32 v140, 0
    v_mov_b32 v141, 0
    v_mov_b32 v142, 0
    v_mov_b32 v143, 0
    v_mov_b32 v144, 0
    v_mov_b32 v145, 0
    v_mov_b32 v146, 0
    v_mov_b32 v147, 0
    v_mov_b32 v148, 0
    v_mov_b32 v149, 0
    v_mov_b32 v150, 0
    v_mov_b32 v151, 0
    v_mov_b32 v152, 0
    v_mov_b32 v153, 0
    v_mov_b32 v154, 0
    v_mov_b32 v155, 0
    v_mov_b32 v156, 0
    v_mov_b32 v157, 0
    v_mov_b32 v158, 0
    v_mov_b32 v159, 0
    v_mov_b32 v160, 0
    v_mov_b32 v161, 0
    v_mov_b32 v162, 0
    v_mov_b32 v163, 0
    v_mov_b32 v164, 0
    v_mov_b32 v165, 0
    v_mov_b32 v166, 0
    v_mov_b32 v167, 0
    v_mov_b32 v168, 0
    v_mov_b32 v169, 0
    v_mov_b32 v170, 0
    v_mov_b32 v171, 0
    v_mov_b32 v172, 0
    v_mov_b32 v173, 0
    v_mov_b32 v174, 0
    v_mov_b32 v175, 0
    v_mov_b32 v176, 0
    v_mov_b32 v177, 0
    v_mov_b32 v178, 0
    v_mov_b32 v179, 0
    v_mov_b32 v180, 0
    v_mov_b32 v181, 0
    v_mov_b32 v182, 0
    v_mov_b32 v183, 0
    v_mov_b32 v184, 0
    v_mov_b32 v185, 0
    v_mov_b32 v186, 0
    v_mov_b32 v187, 0
    v_mov_b32 v188, 0
    v_mov_b32 v189, 0
    v_mov_b32 v190, 0
    v_mov_b32 v191, 0
    v_mov_b32 v192, 0
    v_mov_b32 v193, 0
    v_mov_b32 v194, 0
    v_mov_b32 v195, 0
    v_mov_b32 v196, 0
    v_mov_b32 v197, 0
    v_mov_b32 v198, 0
    v_mov_b32 v199, 0
    v_mov_b32 v200, 0
    v_mov_b32 v201, 0
    v_mov_b32 v202, 0
    v_mov_b32 v203, 0
    v_mov_b32 v204, 0
    v_mov_b32 v205, 0
    v_mov_b32 v206, 0
    v_mov_b32 v207, 0
    v_mov_b32 v208, 0
    v_mov_b32 v209, 0
    v_mov_b32 v210, 0
    v_mov_b32 v211, 0
    v_mov_b32 v212, 0
    v_mov_b32 v213, 0
    v_mov_b32 v214, 0
    v_mov_b32 v215, 0
    v_mov_b32 v216, 0
    v_mov_b32 v217, 0
    v_mov_b32 v218, 0
    v_mov_b32 v219, 0
    v_mov_b32 v220, 0
    v_mov_b32 v221, 0
    v_mov_b32 v222, 0
    v_mov_b32 v223, 0
    s_waitcnt vmcnt(16)
    s_barrier
    v_add_u32 v18, s56, v16
    v_add_u32 v19, s56, v17
    v_add_u32 v24, s56, v20
    v_add_u32 v25, s56, v21
    v_add_u32 v26, s56, v22
    v_add_u32 v27, s56, v23
    s_add_u32 s56, s56, 32768
    s_cmp_eq_u32 s56, 131072
    s_cselect_b32 s56, 0, s56
    ds_read_b128 v[32:35], v18 offset:0
    ds_read_b64_tr_b16 v[48:49], v24 offset:0
    ds_read_b64_tr_b16 v[50:51], v24 offset:1024
    ds_read_b128 v[36:39], v18 offset:2048
    ds_read_b64_tr_b16 v[52:53], v25 offset:0
    ds_read_b64_tr_b16 v[54:55], v25 offset:1024
    ds_read_b128 v[40:43], v18 offset:4096
    ds_read_b64_tr_b16 v[56:57], v26 offset:0
    ds_read_b64_tr_b16 v[58:59], v26 offset:1024
    ds_read_b128 v[44:47], v18 offset:6144
    ds_read_b64_tr_b16 v[60:61], v27 offset:0
    ds_read_b64_tr_b16 v[62:63], v27 offset:1024
    s_cmp_eq_u32 s44, 1
    s_mov_b32 s57, 30
    s_cbranch_scc1 k2_kernel_phB
    s_mov_b32 s57, 16
k2_kernel_loopA:
    s_waitcnt lgkmcnt(0)
    s_waitcnt vmcnt(8)
    s_barrier
    v_mfma_f32_16x16x32_bf16 v[160:163], v[48:51], v[32:35], v[160:163]
    ds_read_b128 v[64:67], v19 offset:0
    s_add_u32 m0, s55, s50
    s_nop 0
    s_nop 0
    buffer_load_dwordx4 v8, s[4:7], s45 offen lds
    v_mfma_f32_16x16x32_bf16 v[164:167], v[52:55], v[32:35], v[164:167]
    ds_read_b64_tr_b16 v[80:81], v24 offset:8192
    v_mfma_f32_16x16x32_bf16 v[168:171], v[56:59], v[32:35], v[168:171]
    ds_read_b64_tr_b16 v[82:83], v24 offset:9216
    s_add_u32 m0, s55, s50
    s_add_u32 m0, m0, 1024
    s_nop 0
    buffer_load_dwordx4 v9, s[4:7], s45 offen lds
    v_mfma_f32_16x16x32_bf16 v[172:175], v[60:63], v[32:35], v[172:175]
    ds_read_b128 v[68:71], v19 offset:2048
    v_mfma_f32_16x16x32_bf16 v[176:179], v[48:51], v[36:39], v[176:179]
    ds_read_b64_tr_b16 v[84:85], v25 offset:8192
    s_add_u32 m0, s55, s50
    s_add_u32 m0, m0, 2048
    s_nop 0
    buffer_load_dwordx4 v10, s[4:7], s45 offen lds
    v_mfma_f32_16x16x32_bf16 v[180:183], v[52:55], v[36:39], v[180:183]
    ds_read_b64_tr_b16 v[86:87], v25 offset:9216
    v_mfma_f32_16x16x32_bf16 v[184:187], v[56:59], v[36:39], v[184:187]
    ds_read_b128 v[72:75], v19 offset:4096
    s_add_u32 m0, s55, s50
    s_add_u32 m0, m0, 3072
    s_nop 0
    buffer_load_dwordx4 v11, s[4:7], s45 offen lds
    v_mfma_f32_16x16x32_bf16 v[188:191], v[60:63], v[36:39], v[188:191]
    ds_read_b64_tr_b16 v[88:89], v26 offset:8192
    v_mfma_f32_16x16x32_bf16 v[192:195], v[48:51], v[40:43], v[192:195]
    ds_read_b64_tr_b16 v[90:91], v26 offset:9216
    s_add_u32 m0, s55, s52
    s_nop 0
    s_nop 0
    buffer_load_dwordx4 v12, s[8:11], s46 offen lds
    v_mfma_f32_16x16x32_bf16 v[196:199], v[52:55], v[40:43], v[196:199]
    ds_read_b128 v[76:79], v19 offset:6144
    v_mfma_f32_16x16x32_bf16 v[200:203], v[56:59], v[40:43], v[200:203]
    ds_read_b64_tr_b16 v[92:93], v27 offset:8192
    s_add_u32 m0, s55, s52
    s_add_u32 m0, m0, 1024
    s_nop 0
    buffer_load_dwordx4 v13, s[8:11], s46 offen lds
    v_mfma_f32_16x16x32_bf16 v[204:207], v[60:63], v[40:43], v[204:207]
    ds_read_b64_tr_b16 v[94:95], v27 offset:9216
    v_mfma_f32_16x16x32_bf16 v[208:211], v[48:51], v[44:47], v[208:211]
    s_add_u32 m0, s55, s52
    s_add_u32 m0, m0, 2048
    s_nop 0
    buffer_load_dwordx4 v14, s[8:11], s46 offen lds
    v_mfma_f32_16x16x32_bf16 v[212:215], v[52:55], v[44:47], v[212:215]
    v_mfma_f32_16x16x32_bf16 v[216:219], v[56:59], v[44:47], v[216:219]
    s_add_u32 m0, s55, s52
    s_add_u32 m0, m0, 3072
    s_nop 0
    buffer_load_dwordx4 v15, s[8:11], s46 offen lds
    v_mfma_f32_16x16x32_bf16 v[220:223], v[60:63], v[44:47], v[220:223]
    s_add_u32 s45, s45, 128
    s_add_u32 s46, s46, 131072
    s_add_u32 s47, s47, 1
    s_cmp_eq_u32 s47, 16
    s_cselect_b32 s8, s14, s8
    s_cselect_b32 s9, s15, s9
    s_cselect_b32 s10, s62, s10
    s_cselect_b32 s46, 0, s46
    s_add_u32 s55, s55, 32768
    s_cmp_eq_u32 s55, 131072
    s_cselect_b32 s55, 0, s55
    s_waitcnt lgkmcnt(0)
    v_add_u32 v18, s56, v16
    v_add_u32 v19, s56, v17
    v_add_u32 v24, s56, v20
    v_add_u32 v25, s56, v21
    v_add_u32 v26, s56, v22
    v_add_u32 v27, s56, v23
    s_add_u32 s56, s56, 32768
    s_cmp_eq_u32 s56, 131072
    s_cselect_b32 s56, 0, s56
    v_mfma_f32_16x16x32_bf16 v[160:163], v[80:83], v[64:67], v[160:163]
    ds_read_b128 v[32:35], v18 offset:0
    v_mfma_f32_16x16x32_bf16 v[164:167], v[84:87], v[64:67], v[164:167]
    ds_read_b64_tr_b16 v[48:49], v24 offset:0
    v_mfma_f32_16x16x32_bf16 v[168:171], v[88:91], v[64:67], v[168:171]
    ds_read_b64_tr_b16 v[50:51], v24 offset:1024
    v_mfma_f32_16x16x32_bf16 v[172:175], v[92:95], v[64:67], v[172:175]
    ds_read_b128 v[36:39], v18 offset:2048
    v_mfma_f32_16x16x32_bf16 v[176:179], v[80:83], v[68:71], v[176:179]
    ds_read_b64_tr_b16 v[52:53], v25 offset:0
    v_mfma_f32_16x16x32_bf16 v[180:183], v[84:87], v[68:71], v[180:183]
    ds_read_b64_tr_b16 v[54:55], v25 offset:1024
    v_mfma_f32_16x16x32_bf16 v[184:187], v[88:91], v[68:71], v[184:187]
    ds_read_b128 v[40:43], v18 offset:4096
    v_mfma_f32_16x16x32_bf16 v[188:191], v[92:95], v[68:71], v[188:191]
    ds_read_b64_tr_b16 v[56:57], v26 offset:0
    v_mfma_f32_16x16x32_bf16 v[192:195], v[80:83], v[72:75], v[192:195]
    ds_read_b64_tr_b16 v[58:59], v26 offset:1024
    v_mfma_f32_16x16x32_bf16 v[196:199], v[84:87], v[72:75], v[196:199]
    ds_read_b128 v[44:47], v18 offset:6144
    v_mfma_f32_16x16x32_bf16 v[200:203], v[88:91], v[72:75], v[200:203]
    ds_read_b64_tr_b16 v[60:61], v27 offset:0
    v_mfma_f32_16x16x32_bf16 v[204:207], v[92:95], v[72:75], v[204:207]
    ds_read_b64_tr_b16 v[62:63], v27 offset:1024
    v_mfma_f32_16x16x32_bf16 v[208:211], v[80:83], v[76:79], v[208:211]
    v_mfma_f32_16x16x32_bf16 v[212:215], v[84:87], v[76:79], v[212:215]
    v_mfma_f32_16x16x32_bf16 v[216:219], v[88:91], v[76:79], v[216:219]
    v_mfma_f32_16x16x32_bf16 v[220:223], v[92:95], v[76:79], v[220:223]
    s_sub_u32 s57, s57, 1
    s_cmp_lg_u32 s57, 0
    s_cbranch_scc1 k2_kernel_loopA
    s_mov_b32 s57, 20
k2_kernel_phB:
    s_waitcnt lgkmcnt(0)
    s_waitcnt vmcnt(8)
    s_barrier
    v_mfma_f32_16x16x32_bf16 v[96:99], v[48:51], v[32:35], v[96:99]
    ds_read_b128 v[64:67], v19 offset:0
    s_add_u32 m0, s55, s50
    s_nop 0
    s_nop 0
    buffer_load_dwordx4 v8, s[4:7], s45 offen lds
    v_mfma_f32_16x16x32_bf16 v[100:103], v[52:55], v[32:35], v[100:103]
    ds_read_b64_tr_b16 v[80:81], v24 offset:8192
    v_mfma_f32_16x16x32_bf16 v[104:107], v[56:59], v[32:35], v[104:107]
    ds_read_b64_tr_b16 v[82:83], v24 offset:9216
    s_add_u32 m0, s55, s50
    s_add_u32 m0, m0, 1024
    s_nop 0
    buffer_load_dwordx4 v9, s[4:7], s45 offen lds
    v_mfma_f32_16x16x32_bf16 v[108:111], v[60:63], v[32:35], v[108:111]
    ds_read_b128 v[68:71], v19 offset:2048
    v_mfma_f32_16x16x32_bf16 v[112:115], v[48:51], v[36:39], v[112:115]
    ds_read_b64_tr_b16 v[84:85], v25 offset:8192
    s_add_u32 m0, s55, s50
    s_add_u32 m0, m0, 2048
    s_nop 0
    buffer_load_dwordx4 v10, s[4:7], s45 offen lds
    v_mfma_f32_16x16x32_bf16 v[116:119], v[52:55], v[36:39], v[116:119]
    ds_read_b64_tr_b16 v[86:87], v25 offset:9216
    v_mfma_f32_16x16x32_bf16 v[120:123], v[56:59], v[36:39], v[120:123]
    ds_read_b128 v[72:75], v19 offset:4096
    s_add_u32 m0, s55, s50
    s_add_u32 m0, m0, 3072
    s_nop 0
    buffer_load_dwordx4 v11, s[4:7], s45 offen lds
    v_mfma_f32_16x16x32_bf16 v[124:127], v[60:63], v[36:39], v[124:127]
    ds_read_b64_tr_b16 v[88:89], v26 offset:8192
    v_mfma_f32_16x16x32_bf16 v[128:131], v[48:51], v[40:43], v[128:131]
    ds_read_b64_tr_b16 v[90:91], v26 offset:9216
    s_add_u32 m0, s55, s52
    s_nop 0
    s_nop 0
    buffer_load_dwordx4 v12, s[8:11], s46 offen lds
    v_mfma_f32_16x16x32_bf16 v[132:135], v[52:55], v[40:43], v[132:135]
    ds_read_b128 v[76:79], v19 offset:6144
    v_mfma_f32_16x16x32_bf16 v[136:139], v[56:59], v[40:43], v[136:139]
    ds_read_b64_tr_b16 v[92:93], v27 offset:8192
    s_add_u32 m0, s55, s52
    s_add_u32 m0, m0, 1024
    s_nop 0
    buffer_load_dwordx4 v13, s[8:11], s46 offen lds
    v_mfma_f32_16x16x32_bf16 v[140:143], v[60:63], v[40:43], v[140:143]
    ds_read_b64_tr_b16 v[94:95], v27 offset:9216
    v_mfma_f32_16x16x32_bf16 v[144:147], v[48:51], v[44:47], v[144:147]
    s_add_u32 m0, s55, s52
    s_add_u32 m0, m0, 2048
    s_nop 0
    buffer_load_dwordx4 v14, s[8:11], s46 offen lds
    v_mfma_f32_16x16x32_bf16 v[148:151], v[52:55], v[44:47], v[148:151]
    v_mfma_f32_16x16x32_bf16 v[152:155], v[56:59], v[44:47], v[152:155]
    s_add_u32 m0, s55, s52
    s_add_u32 m0, m0, 3072
    s_nop 0
    buffer_load_dwordx4 v15, s[8:11], s46 offen lds
    v_mfma_f32_16x16x32_bf16 v[156:159], v[60:63], v[44:47], v[156:159]
    s_add_u32 s45, s45, 128
    s_add_u32 s46, s46, 131072
    s_add_u32 s47, s47, 1
    s_cmp_eq_u32 s47, 16
    s_cselect_b32 s8, s14, s8
    s_cselect_b32 s9, s15, s9
    s_cselect_b32 s10, s62, s10
    s_cselect_b32 s46, 0, s46
    s_add_u32 s55, s55, 32768
    s_cmp_eq_u32 s55, 131072
    s_cselect_b32 s55, 0, s55
    s_waitcnt lgkmcnt(0)
    v_add_u32 v18, s56, v16
    v_add_u32 v19, s56, v17
    v_add_u32 v24, s56, v20
    v_add_u32 v25, s56, v21
    v_add_u32 v26, s56, v22
    v_add_u32 v27, s56, v23
    s_add_u32 s56, s56, 32768
    s_cmp_eq_u32 s56, 131072
    s_cselect_b32 s56, 0, s56
    v_mfma_f32_16x16x32_bf16 v[96:99], v[80:83], v[64:67], v[96:99]
    ds_read_b128 v[32:35], v18 offset:0
    v_mfma_f32_16x16x32_bf16 v[100:103], v[84:87], v[64:67], v[100:103]
    ds_read_b64_tr_b16 v[48:49], v24 offset:0
    v_mfma_f32_16x16x32_bf16 v[104:107], v[88:91], v[64:67], v[104:107]
    ds_read_b64_tr_b16 v[50:51], v24 offset:1024
    v_mfma_f32_16x16x32_bf16 v[108:111], v[92:95], v[64:67], v[108:111]
    ds_read_b128 v[36:39], v18 offset:2048
    v_mfma_f32_16x16x32_bf16 v[112:115], v[80:83], v[68:71], v[112:115]
    ds_read_b64_tr_b16 v[52:53], v25 offset:0
    v_mfma_f32_16x16x32_bf16 v[116:119], v[84:87], v[68:71], v[116:119]
    ds_read_b64_tr_b16 v[54:55], v25 offset:1024
    v_mfma_f32_16x16x32_bf16 v[120:123], v[88:91], v[68:71], v[120:123]
    ds_read_b128 v[40:43], v18 offset:4096
    v_mfma_f32_16x16x32_bf16 v[124:127], v[92:95], v[68:71], v[124:127]
    ds_read_b64_tr_b16 v[56:57], v26 offset:0
    v_mfma_f32_16x16x32_bf16 v[128:131], v[80:83], v[72:75], v[128:131]
    ds_read_b64_tr_b16 v[58:59], v26 offset:1024
    v_mfma_f32_16x16x32_bf16 v[132:135], v[84:87], v[72:75], v[132:135]
    ds_read_b128 v[44:47], v18 offset:6144
    v_mfma_f32_16x16x32_bf16 v[136:139], v[88:91], v[72:75], v[136:139]
    ds_read_b64_tr_b16 v[60:61], v27 offset:0
    v_mfma_f32_16x16x32_bf16 v[140:143], v[92:95], v[72:75], v[140:143]
    ds_read_b64_tr_b16 v[62:63], v27 offset:1024
    v_mfma_f32_16x16x32_bf16 v[144:147], v[80:83], v[76:79], v[144:147]
    v_mfma_f32_16x16x32_bf16 v[148:151], v[84:87], v[76:79], v[148:151]
    v_mfma_f32_16x16x32_bf16 v[152:155], v[88:91], v[76:79], v[152:155]
    v_mfma_f32_16x16x32_bf16 v[156:159], v[92:95], v[76:79], v[156:159]
    s_sub_u32 s57, s57, 1
    s_cmp_lg_u32 s57, 0
    s_cbranch_scc1 k2_kernel_phB
    s_waitcnt lgkmcnt(0)
    s_waitcnt vmcnt(8)
    s_barrier
    v_mfma_f32_16x16x32_bf16 v[96:99], v[48:51], v[32:35], v[96:99]
    ds_read_b128 v[64:67], v19 offset:0
    v_mfma_f32_16x16x32_bf16 v[100:103], v[52:55], v[32:35], v[100:103]
    ds_read_b64_tr_b16 v[80:81], v24 offset:8192
    v_mfma_f32_16x16x32_bf16 v[104:107], v[56:59], v[32:35], v[104:107]
    ds_read_b64_tr_b16 v[82:83], v24 offset:9216
    v_mfma_f32_16x16x32_bf16 v[108:111], v[60:63], v[32:35], v[108:111]
    ds_read_b128 v[68:71], v19 offset:2048
    v_mfma_f32_16x16x32_bf16 v[112:115], v[48:51], v[36:39], v[112:115]
    ds_read_b64_tr_b16 v[84:85], v25 offset:8192
    v_mfma_f32_16x16x32_bf16 v[116:119], v[52:55], v[36:39], v[116:119]
    ds_read_b64_tr_b16 v[86:87], v25 offset:9216
    v_mfma_f32_16x16x32_bf16 v[120:123], v[56:59], v[36:39], v[120:123]
    ds_read_b128 v[72:75], v19 offset:4096
    v_mfma_f32_16x16x32_bf16 v[124:127], v[60:63], v[36:39], v[124:127]
    ds_read_b64_tr_b16 v[88:89], v26 offset:8192
    v_mfma_f32_16x16x32_bf16 v[128:131], v[48:51], v[40:43], v[128:131]
    ds_read_b64_tr_b16 v[90:91], v26 offset:9216
    v_mfma_f32_16x16x32_bf16 v[132:135], v[52:55], v[40:43], v[132:135]
    ds_read_b128 v[76:79], v19 offset:6144
    v_mfma_f32_16x16x32_bf16 v[136:139], v[56:59], v[40:43], v[136:139]
    ds_read_b64_tr_b16 v[92:93], v27 offset:8192
    v_mfma_f32_16x16x32_bf16 v[140:143], v[60:63], v[40:43], v[140:143]
    ds_read_b64_tr_b16 v[94:95], v27 offset:9216
    v_mfma_f32_16x16x32_bf16 v[144:147], v[48:51], v[44:47], v[144:147]
    v_mfma_f32_16x16x32_bf16 v[148:151], v[52:55], v[44:47], v[148:151]
    v_mfma_f32_16x16x32_bf16 v[152:155], v[56:59], v[44:47], v[152:155]
    v_mfma_f32_16x16x32_bf16 v[156:159], v[60:63], v[44:47], v[156:159]
    s_waitcnt lgkmcnt(0)
    v_add_u32 v18, s56, v16
    v_add_u32 v19, s56, v17
    v_add_u32 v24, s56, v20
    v_add_u32 v25, s56, v21
    v_add_u32 v26, s56, v22
    v_add_u32 v27, s56, v23
    s_add_u32 s56, s56, 32768
    s_cmp_eq_u32 s56, 131072
    s_cselect_b32 s56, 0, s56
    v_mfma_f32_16x16x32_bf16 v[96:99], v[80:83], v[64:67], v[96:99]
    ds_read_b128 v[32:35], v18 offset:0
    v_mfma_f32_16x16x32_bf16 v[100:103], v[84:87], v[64:67], v[100:103]
    ds_read_b64_tr_b16 v[48:49], v24 offset:0
    v_mfma_f32_16x16x32_bf16 v[104:107], v[88:91], v[64:67], v[104:107]
    ds_read_b64_tr_b16 v[50:51], v24 offset:1024
    v_mfma_f32_16x16x32_bf16 v[108:111], v[92:95], v[64:67], v[108:111]
    ds_read_b128 v[36:39], v18 offset:2048
    v_mfma_f32_16x16x32_bf16 v[112:115], v[80:83], v[68:71], v[112:115]
    ds_read_b64_tr_b16 v[52:53], v25 offset:0
    v_mfma_f32_16x16x32_bf16 v[116:119], v[84:87], v[68:71], v[116:119]
    ds_read_b64_tr_b16 v[54:55], v25 offset:1024
    v_mfma_f32_16x16x32_bf16 v[120:123], v[88:91], v[68:71], v[120:123]
    ds_read_b128 v[40:43], v18 offset:4096
    v_mfma_f32_16x16x32_bf16 v[124:127], v[92:95], v[68:71], v[124:127]
    ds_read_b64_tr_b16 v[56:57], v26 offset:0
    v_mfma_f32_16x16x32_bf16 v[128:131], v[80:83], v[72:75], v[128:131]
    ds_read_b64_tr_b16 v[58:59], v26 offset:1024
    v_mfma_f32_16x16x32_bf16 v[132:135], v[84:87], v[72:75], v[132:135]
    ds_read_b128 v[44:47], v18 offset:6144
    v_mfma_f32_16x16x32_bf16 v[136:139], v[88:91], v[72:75], v[136:139]
    ds_read_b64_tr_b16 v[60:61], v27 offset:0
    v_mfma_f32_16x16x32_bf16 v[140:143], v[92:95], v[72:75], v[140:143]
    ds_read_b64_tr_b16 v[62:63], v27 offset:1024
    v_mfma_f32_16x16x32_bf16 v[144:147], v[80:83], v[76:79], v[144:147]
    v_mfma_f32_16x16x32_bf16 v[148:151], v[84:87], v[76:79], v[148:151]
    v_mfma_f32_16x16x32_bf16 v[152:155], v[88:91], v[76:79], v[152:155]
    v_mfma_f32_16x16x32_bf16 v[156:159], v[92:95], v[76:79], v[156:159]
    s_waitcnt lgkmcnt(0)
    s_waitcnt vmcnt(0)
    s_barrier
    v_mfma_f32_16x16x32_bf16 v[96:99], v[48:51], v[32:35], v[96:99]
    ds_read_b128 v[64:67], v19 offset:0
    v_mfma_f32_16x16x32_bf16 v[100:103], v[52:55], v[32:35], v[100:103]
    ds_read_b64_tr_b16 v[80:81], v24 offset:8192
    v_mfma_f32_16x16x32_bf16 v[104:107], v[56:59], v[32:35], v[104:107]
    ds_read_b64_tr_b16 v[82:83], v24 offset:9216
    v_mfma_f32_16x16x32_bf16 v[108:111], v[60:63], v[32:35], v[108:111]
    ds_read_b128 v[68:71], v19 offset:2048
    v_mfma_f32_16x16x32_bf16 v[112:115], v[48:51], v[36:39], v[112:115]
    ds_read_b64_tr_b16 v[84:85], v25 offset:8192
    v_mfma_f32_16x16x32_bf16 v[116:119], v[52:55], v[36:39], v[116:119]
    ds_read_b64_tr_b16 v[86:87], v25 offset:9216
    v_mfma_f32_16x16x32_bf16 v[120:123], v[56:59], v[36:39], v[120:123]
    ds_read_b128 v[72:75], v19 offset:4096
    v_mfma_f32_16x16x32_bf16 v[124:127], v[60:63], v[36:39], v[124:127]
    ds_read_b64_tr_b16 v[88:89], v26 offset:8192
    v_mfma_f32_16x16x32_bf16 v[128:131], v[48:51], v[40:43], v[128:131]
    ds_read_b64_tr_b16 v[90:91], v26 offset:9216
    v_mfma_f32_16x16x32_bf16 v[132:135], v[52:55], v[40:43], v[132:135]
    ds_read_b128 v[76:79], v19 offset:6144
    v_mfma_f32_16x16x32_bf16 v[136:139], v[56:59], v[40:43], v[136:139]
    ds_read_b64_tr_b16 v[92:93], v27 offset:8192
    v_mfma_f32_16x16x32_bf16 v[140:143], v[60:63], v[40:43], v[140:143]
    ds_read_b64_tr_b16 v[94:95], v27 offset:9216
    v_mfma_f32_16x16x32_bf16 v[144:147], v[48:51], v[44:47], v[144:147]
    v_mfma_f32_16x16x32_bf16 v[148:151], v[52:55], v[44:47], v[148:151]
    v_mfma_f32_16x16x32_bf16 v[152:155], v[56:59], v[44:47], v[152:155]
    v_mfma_f32_16x16x32_bf16 v[156:159], v[60:63], v[44:47], v[156:159]
    s_waitcnt lgkmcnt(0)
    v_add_u32 v18, s56, v16
    v_add_u32 v19, s56, v17
    v_add_u32 v24, s56, v20
    v_add_u32 v25, s56, v21
    v_add_u32 v26, s56, v22
    v_add_u32 v27, s56, v23
    s_add_u32 s56, s56, 32768
    s_cmp_eq_u32 s56, 131072
    s_cselect_b32 s56, 0, s56
    v_mfma_f32_16x16x32_bf16 v[96:99], v[80:83], v[64:67], v[96:99]
    ds_read_b128 v[32:35], v18 offset:0
    v_mfma_f32_16x16x32_bf16 v[100:103], v[84:87], v[64:67], v[100:103]
    ds_read_b64_tr_b16 v[48:49], v24 offset:0
    v_mfma_f32_16x16x32_bf16 v[104:107], v[88:91], v[64:67], v[104:107]
    ds_read_b64_tr_b16 v[50:51], v24 offset:1024
    v_mfma_f32_16x16x32_bf16 v[108:111], v[92:95], v[64:67], v[108:111]
    ds_read_b128 v[36:39], v18 offset:2048
    v_mfma_f32_16x16x32_bf16 v[112:115], v[80:83], v[68:71], v[112:115]
    ds_read_b64_tr_b16 v[52:53], v25 offset:0
    v_mfma_f32_16x16x32_bf16 v[116:119], v[84:87], v[68:71], v[116:119]
    ds_read_b64_tr_b16 v[54:55], v25 offset:1024
    v_mfma_f32_16x16x32_bf16 v[120:123], v[88:91], v[68:71], v[120:123]
    ds_read_b128 v[40:43], v18 offset:4096
    v_mfma_f32_16x16x32_bf16 v[124:127], v[92:95], v[68:71], v[124:127]
    ds_read_b64_tr_b16 v[56:57], v26 offset:0
    v_mfma_f32_16x16x32_bf16 v[128:131], v[80:83], v[72:75], v[128:131]
    ds_read_b64_tr_b16 v[58:59], v26 offset:1024
    v_mfma_f32_16x16x32_bf16 v[132:135], v[84:87], v[72:75], v[132:135]
    ds_read_b128 v[44:47], v18 offset:6144
    v_mfma_f32_16x16x32_bf16 v[136:139], v[88:91], v[72:75], v[136:139]
    ds_read_b64_tr_b16 v[60:61], v27 offset:0
    v_mfma_f32_16x16x32_bf16 v[140:143], v[92:95], v[72:75], v[140:143]
    ds_read_b64_tr_b16 v[62:63], v27 offset:1024
    v_mfma_f32_16x16x32_bf16 v[144:147], v[80:83], v[76:79], v[144:147]
    v_mfma_f32_16x16x32_bf16 v[148:151], v[84:87], v[76:79], v[148:151]
    v_mfma_f32_16x16x32_bf16 v[152:155], v[88:91], v[76:79], v[152:155]
    v_mfma_f32_16x16x32_bf16 v[156:159], v[92:95], v[76:79], v[156:159]
    s_waitcnt lgkmcnt(0)
    v_mfma_f32_16x16x32_bf16 v[96:99], v[48:51], v[32:35], v[96:99]
    ds_read_b128 v[64:67], v19 offset:0
    v_mfma_f32_16x16x32_bf16 v[100:103], v[52:55], v[32:35], v[100:103]
    ds_read_b64_tr_b16 v[80:81], v24 offset:8192
    v_mfma_f32_16x16x32_bf16 v[104:107], v[56:59], v[32:35], v[104:107]
    ds_read_b64_tr_b16 v[82:83], v24 offset:9216
    v_mfma_f32_16x16x32_bf16 v[108:111], v[60:63], v[32:35], v[108:111]
    ds_read_b128 v[68:71], v19 offset:2048
    v_mfma_f32_16x16x32_bf16 v[112:115], v[48:51], v[36:39], v[112:115]
    ds_read_b64_tr_b16 v[84:85], v25 offset:8192
    v_mfma_f32_16x16x32_bf16 v[116:119], v[52:55], v[36:39], v[116:119]
    ds_read_b64_tr_b16 v[86:87], v25 offset:9216
    v_mfma_f32_16x16x32_bf16 v[120:123], v[56:59], v[36:39], v[120:123]
    ds_read_b128 v[72:75], v19 offset:4096
    v_mfma_f32_16x16x32_bf16 v[124:127], v[60:63], v[36:39], v[124:127]
    ds_read_b64_tr_b16 v[88:89], v26 offset:8192
    v_mfma_f32_16x16x32_bf16 v[128:131], v[48:51], v[40:43], v[128:131]
    ds_read_b64_tr_b16 v[90:91], v26 offset:9216
    v_mfma_f32_16x16x32_bf16 v[132:135], v[52:55], v[40:43], v[132:135]
    ds_read_b128 v[76:79], v19 offset:6144
    v_mfma_f32_16x16x32_bf16 v[136:139], v[56:59], v[40:43], v[136:139]
    ds_read_b64_tr_b16 v[92:93], v27 offset:8192
    v_mfma_f32_16x16x32_bf16 v[140:143], v[60:63], v[40:43], v[140:143]
    ds_read_b64_tr_b16 v[94:95], v27 offset:9216
    v_mfma_f32_16x16x32_bf16 v[144:147], v[48:51], v[44:47], v[144:147]
    v_mfma_f32_16x16x32_bf16 v[148:151], v[52:55], v[44:47], v[148:151]
    v_mfma_f32_16x16x32_bf16 v[152:155], v[56:59], v[44:47], v[152:155]
    v_mfma_f32_16x16x32_bf16 v[156:159], v[60:63], v[44:47], v[156:159]
    s_waitcnt lgkmcnt(0)
    v_mfma_f32_16x16x32_bf16 v[96:99], v[80:83], v[64:67], v[96:99]
    v_mfma_f32_16x16x32_bf16 v[100:103], v[84:87], v[64:67], v[100:103]
    v_mfma_f32_16x16x32_bf16 v[104:107], v[88:91], v[64:67], v[104:107]
    v_mfma_f32_16x16x32_bf16 v[108:111], v[92:95], v[64:67], v[108:111]
    v_mfma_f32_16x16x32_bf16 v[112:115], v[80:83], v[68:71], v[112:115]
    v_mfma_f32_16x16x32_bf16 v[116:119], v[84:87], v[68:71], v[116:119]
    v_mfma_f32_16x16x32_bf16 v[120:123], v[88:91], v[68:71], v[120:123]
    v_mfma_f32_16x16x32_bf16 v[124:127], v[92:95], v[68:71], v[124:127]
    v_mfma_f32_16x16x32_bf16 v[128:131], v[80:83], v[72:75], v[128:131]
    v_mfma_f32_16x16x32_bf16 v[132:135], v[84:87], v[72:75], v[132:135]
    v_mfma_f32_16x16x32_bf16 v[136:139], v[88:91], v[72:75], v[136:139]
    v_mfma_f32_16x16x32_bf16 v[140:143], v[92:95], v[72:75], v[140:143]
    v_mfma_f32_16x16x32_bf16 v[144:147], v[80:83], v[76:79], v[144:147]
    v_mfma_f32_16x16x32_bf16 v[148:151], v[84:87], v[76:79], v[148:151]
    v_mfma_f32_16x16x32_bf16 v[152:155], v[88:91], v[76:79], v[152:155]
    v_mfma_f32_16x16x32_bf16 v[156:159], v[92:95], v[76:79], v[156:159]
    v_lshlrev_b32 v22, 4, v1
    s_lshl_b32 s63, s38, 3
    s_add_u32 s63, s63, s39
    s_lshl_b32 s64, s63, 16
    s_lshl_b32 s59, s40, 14
    s_add_u32 s64, s64, s59
    s_add_u32 s64, s64, 20455424
    s_lshr_b32 s65, s63, 5
    s_lshl_b32 s65, s65, 2
    s_and_b32 s66, s63, 31
    s_lshl_b32 s66, 1, s66
    v_mov_b32 v25, 0
    s_cmp_eq_u32 s44, 0
    s_cbranch_scc1 k2_kernel_cons
    buffer_store_dwordx4 v[96:99], v22, s[20:23], s64 offen offset:0 sc1
    buffer_store_dwordx4 v[100:103], v22, s[20:23], s64 offen offset:1024 sc1
    buffer_store_dwordx4 v[104:107], v22, s[20:23], s64 offen offset:2048 sc1
    buffer_store_dwordx4 v[108:111], v22, s[20:23], s64 offen offset:3072 sc1
    s_add_u32 s64, s64, 4096
    buffer_store_dwordx4 v[112:115], v22, s[20:23], s64 offen offset:0 sc1
    buffer_store_dwordx4 v[116:119], v22, s[20:23], s64 offen offset:1024 sc1
    buffer_store_dwordx4 v[120:123], v22, s[20:23], s64 offen offset:2048 sc1
    buffer_store_dwordx4 v[124:127], v22, s[20:23], s64 offen offset:3072 sc1
    s_add_u32 s64, s64, 4096
    buffer_store_dwordx4 v[128:131], v22, s[20:23], s64 offen offset:0 sc1
    buffer_store_dwordx4 v[132:135], v22, s[20:23], s64 offen offset:1024 sc1
    buffer_store_dwordx4 v[136:139], v22, s[20:23], s64 offen offset:2048 sc1
    buffer_store_dwordx4 v[140:143], v22, s[20:23], s64 offen offset:3072 sc1
    s_add_u32 s64, s64, 4096
    buffer_store_dwordx4 v[144:147], v22, s[20:23], s64 offen offset:0 sc1
    buffer_store_dwordx4 v[148:151], v22, s[20:23], s64 offen offset:1024 sc1
    buffer_store_dwordx4 v[152:155], v22, s[20:23], s64 offen offset:2048 sc1
    buffer_store_dwordx4 v[156:159], v22, s[20:23], s64 offen offset:3072 sc1
    s_add_u32 s64, s64, 4096
    s_waitcnt vmcnt(0)
    s_barrier
    s_cmp_lg_u32 s40, 0
    s_cbranch_scc1 k2_kernel_done
    v_mov_b32 v24, s66
    s_mov_b64 exec, 1
    buffer_atomic_or v24, v25, s[24:27], s65 offen sc1
    s_branch k2_kernel_done
k2_kernel_cons:
    s_lshl_b32 s58, s38, 7
    s_lshl_b32 s59, s41, 6
    s_add_u32 s58, s58, s59
    s_lshl_b32 s59, s58, 2
    s_add_u32 s59, s59, 20447232
    v_lshlrev_b32 v26, 2, v5
    buffer_load_dword v8, v26, s[20:23], s59 offen
    buffer_load_dword v9, v26, s[20:23], s59 offen offset:64
    buffer_load_dword v10, v26, s[20:23], s59 offen offset:128
    buffer_load_dword v11, v26, s[20:23], s59 offen offset:192
    s_lshl_b32 s67, s58, 11
    s_lshl_b32 s59, s39, 8
    s_add_u32 s67, s67, s59
    s_lshl_b32 s59, s42, 7
    s_add_u32 s67, s67, s59
    v_lshlrev_b32 v26, 11, v5
    v_and_b32 v27, 1, v2
    v_lshlrev_b32 v27, 5, v27
    v_add_u32 v26, v26, v27
    v_lshrrev_b32 v27, 1, v2
    v_lshlrev_b32 v27, 4, v27
    v_add_u32 v26, v26, v27
poll_20:
    buffer_load_dword v24, v25, s[24:27], s65 offen sc1
    s_waitcnt vmcnt(0)
    v_readfirstlane_b32 s58, v24
    s_and_b32 s58, s58, s66
    s_cbranch_scc1 poll_20_ok
    s_sleep 2
    s_branch poll_20
poll_20_ok:
    buffer_load_dwordx4 v[32:35], v22, s[20:23], s64 offen offset:0 sc1
    buffer_load_dwordx4 v[36:39], v22, s[20:23], s64 offen offset:1024 sc1
    buffer_load_dwordx4 v[40:43], v22, s[20:23], s64 offen offset:2048 sc1
    buffer_load_dwordx4 v[44:47], v22, s[20:23], s64 offen offset:3072 sc1
    s_add_u32 s64, s64, 4096
    buffer_load_dwordx4 v[48:51], v22, s[20:23], s64 offen offset:0 sc1
    buffer_load_dwordx4 v[52:55], v22, s[20:23], s64 offen offset:1024 sc1
    buffer_load_dwordx4 v[56:59], v22, s[20:23], s64 offen offset:2048 sc1
    buffer_load_dwordx4 v[60:63], v22, s[20:23], s64 offen offset:3072 sc1
    s_add_u32 s64, s64, 4096
    buffer_load_dwordx4 v[64:67], v22, s[20:23], s64 offen offset:0 sc1
    buffer_load_dwordx4 v[68:71], v22, s[20:23], s64 offen offset:1024 sc1
    buffer_load_dwordx4 v[72:75], v22, s[20:23], s64 offen offset:2048 sc1
    buffer_load_dwordx4 v[76:79], v22, s[20:23], s64 offen offset:3072 sc1
    s_add_u32 s64, s64, 4096
    buffer_load_dwordx4 v[80:83], v22, s[20:23], s64 offen offset:0 sc1
    buffer_load_dwordx4 v[84:87], v22, s[20:23], s64 offen offset:1024 sc1
    buffer_load_dwordx4 v[88:91], v22, s[20:23], s64 offen offset:2048 sc1
    buffer_load_dwordx4 v[92:95], v22, s[20:23], s64 offen offset:3072 sc1
    s_add_u32 s64, s64, 4096
    v_sub_f32 v12, 1.0, v8
    v_cvt_pk_bf16_f32 v12, v12, v12
    v_lshlrev_b32 v12, 16, v12
    v_sub_f32 v13, 1.0, v9
    v_cvt_pk_bf16_f32 v13, v13, v13
    v_lshlrev_b32 v13, 16, v13
    v_sub_f32 v14, 1.0, v10
    v_cvt_pk_bf16_f32 v14, v14, v14
    v_lshlrev_b32 v14, 16, v14
    v_sub_f32 v15, 1.0, v11
    v_cvt_pk_bf16_f32 v15, v15, v15
    v_lshlrev_b32 v15, 16, v15
    v_cvt_pk_bf16_f32 v28, v160, v161
    v_cvt_pk_bf16_f32 v29, v162, v163
    v_lshlrev_b32 v160, 16, v28
    v_and_b32 v161, 0xffff0000, v28
    v_lshlrev_b32 v162, 16, v29
    v_and_b32 v163, 0xffff0000, v29
    v_mul_f32 v160, v8, v160
    v_mul_f32 v161, v8, v161
    v_mul_f32 v162, v8, v162
    v_mul_f32 v163, v8, v163
    v_cvt_pk_bf16_f32 v28, v160, v161
    v_cvt_pk_bf16_f32 v29, v162, v163
    v_lshlrev_b32 v160, 16, v28
    v_and_b32 v161, 0xffff0000, v28
    v_lshlrev_b32 v162, 16, v29
    v_and_b32 v163, 0xffff0000, v29
    v_cvt_pk_bf16_f32 v28, v164, v165
    v_cvt_pk_bf16_f32 v29, v166, v167
    v_lshlrev_b32 v164, 16, v28
    v_and_b32 v165, 0xffff0000, v28
    v_lshlrev_b32 v166, 16, v29
    v_and_b32 v167, 0xffff0000, v29
    v_mul_f32 v164, v8, v164
    v_mul_f32 v165, v8, v165
    v_mul_f32 v166, v8, v166
    v_mul_f32 v167, v8, v167
    v_cvt_pk_bf16_f32 v28, v164, v165
    v_cvt_pk_bf16_f32 v29, v166, v167
    v_lshlrev_b32 v164, 16, v28
    v_and_b32 v165, 0xffff0000, v28
    v_lshlrev_b32 v166, 16, v29
    v_and_b32 v167, 0xffff0000, v29
    v_cvt_pk_bf16_f32 v28, v168, v169
    v_cvt_pk_bf16_f32 v29, v170, v171
    v_lshlrev_b32 v168, 16, v28
    v_and_b32 v169, 0xffff0000, v28
    v_lshlrev_b32 v170, 16, v29
    v_and_b32 v171, 0xffff0000, v29
    v_mul_f32 v168, v8, v168
    v_mul_f32 v169, v8, v169
    v_mul_f32 v170, v8, v170
    v_mul_f32 v171, v8, v171
    v_cvt_pk_bf16_f32 v28, v168, v169
    v_cvt_pk_bf16_f32 v29, v170, v171
    v_lshlrev_b32 v168, 16, v28
    v_and_b32 v169, 0xffff0000, v28
    v_lshlrev_b32 v170, 16, v29
    v_and_b32 v171, 0xffff0000, v29
    v_cvt_pk_bf16_f32 v28, v172, v173
    v_cvt_pk_bf16_f32 v29, v174, v175
    v_lshlrev_b32 v172, 16, v28
    v_and_b32 v173, 0xffff0000, v28
    v_lshlrev_b32 v174, 16, v29
    v_and_b32 v175, 0xffff0000, v29
    v_mul_f32 v172, v8, v172
    v_mul_f32 v173, v8, v173
    v_mul_f32 v174, v8, v174
    v_mul_f32 v175, v8, v175
    v_cvt_pk_bf16_f32 v28, v172, v173
    v_cvt_pk_bf16_f32 v29, v174, v175
    v_lshlrev_b32 v172, 16, v28
    v_and_b32 v173, 0xffff0000, v28
    v_lshlrev_b32 v174, 16, v29
    v_and_b32 v175, 0xffff0000, v29
    v_cvt_pk_bf16_f32 v28, v176, v177
    v_cvt_pk_bf16_f32 v29, v178, v179
    v_lshlrev_b32 v176, 16, v28
    v_and_b32 v177, 0xffff0000, v28
    v_lshlrev_b32 v178, 16, v29
    v_and_b32 v179, 0xffff0000, v29
    v_mul_f32 v176, v9, v176
    v_mul_f32 v177, v9, v177
    v_mul_f32 v178, v9, v178
    v_mul_f32 v179, v9, v179
    v_cvt_pk_bf16_f32 v28, v176, v177
    v_cvt_pk_bf16_f32 v29, v178, v179
    v_lshlrev_b32 v176, 16, v28
    v_and_b32 v177, 0xffff0000, v28
    v_lshlrev_b32 v178, 16, v29
    v_and_b32 v179, 0xffff0000, v29
    v_cvt_pk_bf16_f32 v28, v180, v181
    v_cvt_pk_bf16_f32 v29, v182, v183
    v_lshlrev_b32 v180, 16, v28
    v_and_b32 v181, 0xffff0000, v28
    v_lshlrev_b32 v182, 16, v29
    v_and_b32 v183, 0xffff0000, v29
    v_mul_f32 v180, v9, v180
    v_mul_f32 v181, v9, v181
    v_mul_f32 v182, v9, v182
    v_mul_f32 v183, v9, v183
    v_cvt_pk_bf16_f32 v28, v180, v181
    v_cvt_pk_bf16_f32 v29, v182, v183
    v_lshlrev_b32 v180, 16, v28
    v_and_b32 v181, 0xffff0000, v28
    v_lshlrev_b32 v182, 16, v29
    v_and_b32 v183, 0xffff0000, v29
    v_cvt_pk_bf16_f32 v28, v184, v185
    v_cvt_pk_bf16_f32 v29, v186, v187
    v_lshlrev_b32 v184, 16, v28
    v_and_b32 v185, 0xffff0000, v28
    v_lshlrev_b32 v186, 16, v29
    v_and_b32 v187, 0xffff0000, v29
    v_mul_f32 v184, v9, v184
    v_mul_f32 v185, v9, v185
    v_mul_f32 v186, v9, v186
    v_mul_f32 v187, v9, v187
    v_cvt_pk_bf16_f32 v28, v184, v185
    v_cvt_pk_bf16_f32 v29, v186, v187
    v_lshlrev_b32 v184, 16, v28
    v_and_b32 v185, 0xffff0000, v28
    v_lshlrev_b32 v186, 16, v29
    v_and_b32 v187, 0xffff0000, v29
    v_cvt_pk_bf16_f32 v28, v188, v189
    v_cvt_pk_bf16_f32 v29, v190, v191
    v_lshlrev_b32 v188, 16, v28
    v_and_b32 v189, 0xffff0000, v28
    v_lshlrev_b32 v190, 16, v29
    v_and_b32 v191, 0xffff0000, v29
    v_mul_f32 v188, v9, v188
    v_mul_f32 v189, v9, v189
    v_mul_f32 v190, v9, v190
    v_mul_f32 v191, v9, v191
    v_cvt_pk_bf16_f32 v28, v188, v189
    v_cvt_pk_bf16_f32 v29, v190, v191
    v_lshlrev_b32 v188, 16, v28
    v_and_b32 v189, 0xffff0000, v28
    v_lshlrev_b32 v190, 16, v29
    v_and_b32 v191, 0xffff0000, v29
    v_cvt_pk_bf16_f32 v28, v192, v193
    v_cvt_pk_bf16_f32 v29, v194, v195
    v_lshlrev_b32 v192, 16, v28
    v_and_b32 v193, 0xffff0000, v28
    v_lshlrev_b32 v194, 16, v29
    v_and_b32 v195, 0xffff0000, v29
    v_mul_f32 v192, v10, v192
    v_mul_f32 v193, v10, v193
    v_mul_f32 v194, v10, v194
    v_mul_f32 v195, v10, v195
    v_cvt_pk_bf16_f32 v28, v192, v193
    v_cvt_pk_bf16_f32 v29, v194, v195
    v_lshlrev_b32 v192, 16, v28
    v_and_b32 v193, 0xffff0000, v28
    v_lshlrev_b32 v194, 16, v29
    v_and_b32 v195, 0xffff0000, v29
    v_cvt_pk_bf16_f32 v28, v196, v197
    v_cvt_pk_bf16_f32 v29, v198, v199
    v_lshlrev_b32 v196, 16, v28
    v_and_b32 v197, 0xffff0000, v28
    v_lshlrev_b32 v198, 16, v29
    v_and_b32 v199, 0xffff0000, v29
    v_mul_f32 v196, v10, v196
    v_mul_f32 v197, v10, v197
    v_mul_f32 v198, v10, v198
    v_mul_f32 v199, v10, v199
    v_cvt_pk_bf16_f32 v28, v196, v197
    v_cvt_pk_bf16_f32 v29, v198, v199
    v_lshlrev_b32 v196, 16, v28
    v_and_b32 v197, 0xffff0000, v28
    v_lshlrev_b32 v198, 16, v29
    v_and_b32 v199, 0xffff0000, v29
    v_cvt_pk_bf16_f32 v28, v200, v201
    v_cvt_pk_bf16_f32 v29, v202, v203
    v_lshlrev_b32 v200, 16, v28
    v_and_b32 v201, 0xffff0000, v28
    v_lshlrev_b32 v202, 16, v29
    v_and_b32 v203, 0xffff0000, v29
    v_mul_f32 v200, v10, v200
    v_mul_f32 v201, v10, v201
    v_mul_f32 v202, v10, v202
    v_mul_f32 v203, v10, v203
    v_cvt_pk_bf16_f32 v28, v200, v201
    v_cvt_pk_bf16_f32 v29, v202, v203
    v_lshlrev_b32 v200, 16, v28
    v_and_b32 v201, 0xffff0000, v28
    v_lshlrev_b32 v202, 16, v29
    v_and_b32 v203, 0xffff0000, v29
    v_cvt_pk_bf16_f32 v28, v204, v205
    v_cvt_pk_bf16_f32 v29, v206, v207
    v_lshlrev_b32 v204, 16, v28
    v_and_b32 v205, 0xffff0000, v28
    v_lshlrev_b32 v206, 16, v29
    v_and_b32 v207, 0xffff0000, v29
    v_mul_f32 v204, v10, v204
    v_mul_f32 v205, v10, v205
    v_mul_f32 v206, v10, v206
    v_mul_f32 v207, v10, v207
    v_cvt_pk_bf16_f32 v28, v204, v205
    v_cvt_pk_bf16_f32 v29, v206, v207
    v_lshlrev_b32 v204, 16, v28
    v_and_b32 v205, 0xffff0000, v28
    v_lshlrev_b32 v206, 16, v29
    v_and_b32 v207, 0xffff0000, v29
    v_cvt_pk_bf16_f32 v28, v208, v209
    v_cvt_pk_bf16_f32 v29, v210, v211
    v_lshlrev_b32 v208, 16, v28
    v_and_b32 v209, 0xffff0000, v28
    v_lshlrev_b32 v210, 16, v29
    v_and_b32 v211, 0xffff0000, v29
    v_mul_f32 v208, v11, v208
    v_mul_f32 v209, v11, v209
    v_mul_f32 v210, v11, v210
    v_mul_f32 v211, v11, v211
    v_cvt_pk_bf16_f32 v28, v208, v209
    v_cvt_pk_bf16_f32 v29, v210, v211
    v_lshlrev_b32 v208, 16, v28
    v_and_b32 v209, 0xffff0000, v28
    v_lshlrev_b32 v210, 16, v29
    v_and_b32 v211, 0xffff0000, v29
    v_cvt_pk_bf16_f32 v28, v212, v213
    v_cvt_pk_bf16_f32 v29, v214, v215
    v_lshlrev_b32 v212, 16, v28
    v_and_b32 v213, 0xffff0000, v28
    v_lshlrev_b32 v214, 16, v29
    v_and_b32 v215, 0xffff0000, v29
    v_mul_f32 v212, v11, v212
    v_mul_f32 v213, v11, v213
    v_mul_f32 v214, v11, v214
    v_mul_f32 v215, v11, v215
    v_cvt_pk_bf16_f32 v28, v212, v213
    v_cvt_pk_bf16_f32 v29, v214, v215
    v_lshlrev_b32 v212, 16, v28
    v_and_b32 v213, 0xffff0000, v28
    v_lshlrev_b32 v214, 16, v29
    v_and_b32 v215, 0xffff0000, v29
    v_cvt_pk_bf16_f32 v28, v216, v217
    v_cvt_pk_bf16_f32 v29, v218, v219
    v_lshlrev_b32 v216, 16, v28
    v_and_b32 v217, 0xffff0000, v28
    v_lshlrev_b32 v218, 16, v29
    v_and_b32 v219, 0xffff0000, v29
    v_mul_f32 v216, v11, v216
    v_mul_f32 v217, v11, v217
    v_mul_f32 v218, v11, v218
    v_mul_f32 v219, v11, v219
    v_cvt_pk_bf16_f32 v28, v216, v217
    v_cvt_pk_bf16_f32 v29, v218, v219
    v_lshlrev_b32 v216, 16, v28
    v_and_b32 v217, 0xffff0000, v28
    v_lshlrev_b32 v218, 16, v29
    v_and_b32 v219, 0xffff0000, v29
    v_cvt_pk_bf16_f32 v28, v220, v221
    v_cvt_pk_bf16_f32 v29, v222, v223
    v_lshlrev_b32 v220, 16, v28
    v_and_b32 v221, 0xffff0000, v28
    v_lshlrev_b32 v222, 16, v29
    v_and_b32 v223, 0xffff0000, v29
    v_mul_f32 v220, v11, v220
    v_mul_f32 v221, v11, v221
    v_mul_f32 v222, v11, v222
    v_mul_f32 v223, v11, v223
    v_cvt_pk_bf16_f32 v28, v220, v221
    v_cvt_pk_bf16_f32 v29, v222, v223
    v_lshlrev_b32 v220, 16, v28
    v_and_b32 v221, 0xffff0000, v28
    v_lshlrev_b32 v222, 16, v29
    v_and_b32 v223, 0xffff0000, v29
    s_waitcnt vmcnt(15)
    v_add_f32 v96, v96, v32
    v_add_f32 v97, v97, v33
    v_add_f32 v98, v98, v34
    v_add_f32 v99, v99, v35
    v_cvt_pk_bf16_f32 v28, v96, v97
    v_cvt_pk_bf16_f32 v29, v98, v99
    v_lshlrev_b32 v96, 16, v28
    v_and_b32 v97, 0xffff0000, v28
    v_lshlrev_b32 v98, 16, v29
    v_and_b32 v99, 0xffff0000, v29
    v_mul_f32 v96, v12, v96
    v_mul_f32 v97, v12, v97
    v_mul_f32 v98, v12, v98
    v_mul_f32 v99, v12, v99
    v_cvt_pk_bf16_f32 v28, v96, v97
    v_cvt_pk_bf16_f32 v29, v98, v99
    v_lshlrev_b32 v96, 16, v28
    v_and_b32 v97, 0xffff0000, v28
    v_lshlrev_b32 v98, 16, v29
    v_and_b32 v99, 0xffff0000, v29
    v_add_f32 v96, v96, v160
    v_add_f32 v97, v97, v161
    v_add_f32 v98, v98, v162
    v_add_f32 v99, v99, v163
    v_cvt_pk_bf16_f32 v224, v96, v97
    v_cvt_pk_bf16_f32 v225, v98, v99
    s_waitcnt vmcnt(14)
    v_add_f32 v100, v100, v36
    v_add_f32 v101, v101, v37
    v_add_f32 v102, v102, v38
    v_add_f32 v103, v103, v39
    v_cvt_pk_bf16_f32 v28, v100, v101
    v_cvt_pk_bf16_f32 v29, v102, v103
    v_lshlrev_b32 v100, 16, v28
    v_and_b32 v101, 0xffff0000, v28
    v_lshlrev_b32 v102, 16, v29
    v_and_b32 v103, 0xffff0000, v29
    v_mul_f32 v100, v12, v100
    v_mul_f32 v101, v12, v101
    v_mul_f32 v102, v12, v102
    v_mul_f32 v103, v12, v103
    v_cvt_pk_bf16_f32 v28, v100, v101
    v_cvt_pk_bf16_f32 v29, v102, v103
    v_lshlrev_b32 v100, 16, v28
    v_and_b32 v101, 0xffff0000, v28
    v_lshlrev_b32 v102, 16, v29
    v_and_b32 v103, 0xffff0000, v29
    v_add_f32 v100, v100, v164
    v_add_f32 v101, v101, v165
    v_add_f32 v102, v102, v166
    v_add_f32 v103, v103, v167
    v_cvt_pk_bf16_f32 v226, v100, v101
    v_cvt_pk_bf16_f32 v227, v102, v103
    s_nop 1
    v_permlane16_swap_b32 v224, v226
    v_permlane16_swap_b32 v225, v227
    buffer_store_dwordx4 v[224:227], v26, s[16:19], s67 offen offset:0
    s_waitcnt vmcnt(14)
    v_add_f32 v104, v104, v40
    v_add_f32 v105, v105, v41
    v_add_f32 v106, v106, v42
    v_add_f32 v107, v107, v43
    v_cvt_pk_bf16_f32 v28, v104, v105
    v_cvt_pk_bf16_f32 v29, v106, v107
    v_lshlrev_b32 v104, 16, v28
    v_and_b32 v105, 0xffff0000, v28
    v_lshlrev_b32 v106, 16, v29
    v_and_b32 v107, 0xffff0000, v29
    v_mul_f32 v104, v12, v104
    v_mul_f32 v105, v12, v105
    v_mul_f32 v106, v12, v106
    v_mul_f32 v107, v12, v107
    v_cvt_pk_bf16_f32 v28, v104, v105
    v_cvt_pk_bf16_f32 v29, v106, v107
    v_lshlrev_b32 v104, 16, v28
    v_and_b32 v105, 0xffff0000, v28
    v_lshlrev_b32 v106, 16, v29
    v_and_b32 v107, 0xffff0000, v29
    v_add_f32 v104, v104, v168
    v_add_f32 v105, v105, v169
    v_add_f32 v106, v106, v170
    v_add_f32 v107, v107, v171
    v_cvt_pk_bf16_f32 v228, v104, v105
    v_cvt_pk_bf16_f32 v229, v106, v107
    s_waitcnt vmcnt(13)
    v_add_f32 v108, v108, v44
    v_add_f32 v109, v109, v45
    v_add_f32 v110, v110, v46
    v_add_f32 v111, v111, v47
    v_cvt_pk_bf16_f32 v28, v108, v109
    v_cvt_pk_bf16_f32 v29, v110, v111
    v_lshlrev_b32 v108, 16, v28
    v_and_b32 v109, 0xffff0000, v28
    v_lshlrev_b32 v110, 16, v29
    v_and_b32 v111, 0xffff0000, v29
    v_mul_f32 v108, v12, v108
    v_mul_f32 v109, v12, v109
    v_mul_f32 v110, v12, v110
    v_mul_f32 v111, v12, v111
    v_cvt_pk_bf16_f32 v28, v108, v109
    v_cvt_pk_bf16_f32 v29, v110, v111
    v_lshlrev_b32 v108, 16, v28
    v_and_b32 v109, 0xffff0000, v28
    v_lshlrev_b32 v110, 16, v29
    v_and_b32 v111, 0xffff0000, v29
    v_add_f32 v108, v108, v172
    v_add_f32 v109, v109, v173
    v_add_f32 v110, v110, v174
    v_add_f32 v111, v111, v175
    v_cvt_pk_bf16_f32 v230, v108, v109
    v_cvt_pk_bf16_f32 v231, v110, v111
    s_nop 1
    v_permlane16_swap_b32 v228, v230
    v_permlane16_swap_b32 v229, v231
    buffer_store_dwordx4 v[228:231], v26, s[16:19], s67 offen offset:64
    s_add_u32 s67, s67, 32768
    s_waitcnt vmcnt(13)
    v_add_f32 v112, v112, v48
    v_add_f32 v113, v113, v49
    v_add_f32 v114, v114, v50
    v_add_f32 v115, v115, v51
    v_cvt_pk_bf16_f32 v28, v112, v113
    v_cvt_pk_bf16_f32 v29, v114, v115
    v_lshlrev_b32 v112, 16, v28
    v_and_b32 v113, 0xffff0000, v28
    v_lshlrev_b32 v114, 16, v29
    v_and_b32 v115, 0xffff0000, v29
    v_mul_f32 v112, v13, v112
    v_mul_f32 v113, v13, v113
    v_mul_f32 v114, v13, v114
    v_mul_f32 v115, v13, v115
    v_cvt_pk_bf16_f32 v28, v112, v113
    v_cvt_pk_bf16_f32 v29, v114, v115
    v_lshlrev_b32 v112, 16, v28
    v_and_b32 v113, 0xffff0000, v28
    v_lshlrev_b32 v114, 16, v29
    v_and_b32 v115, 0xffff0000, v29
    v_add_f32 v112, v112, v176
    v_add_f32 v113, v113, v177
    v_add_f32 v114, v114, v178
    v_add_f32 v115, v115, v179
    v_cvt_pk_bf16_f32 v232, v112, v113
    v_cvt_pk_bf16_f32 v233, v114, v115
    s_waitcnt vmcnt(12)
    v_add_f32 v116, v116, v52
    v_add_f32 v117, v117, v53
    v_add_f32 v118, v118, v54
    v_add_f32 v119, v119, v55
    v_cvt_pk_bf16_f32 v28, v116, v117
    v_cvt_pk_bf16_f32 v29, v118, v119
    v_lshlrev_b32 v116, 16, v28
    v_and_b32 v117, 0xffff0000, v28
    v_lshlrev_b32 v118, 16, v29
    v_and_b32 v119, 0xffff0000, v29
    v_mul_f32 v116, v13, v116
    v_mul_f32 v117, v13, v117
    v_mul_f32 v118, v13, v118
    v_mul_f32 v119, v13, v119
    v_cvt_pk_bf16_f32 v28, v116, v117
    v_cvt_pk_bf16_f32 v29, v118, v119
    v_lshlrev_b32 v116, 16, v28
    v_and_b32 v117, 0xffff0000, v28
    v_lshlrev_b32 v118, 16, v29
    v_and_b32 v119, 0xffff0000, v29
    v_add_f32 v116, v116, v180
    v_add_f32 v117, v117, v181
    v_add_f32 v118, v118, v182
    v_add_f32 v119, v119, v183
    v_cvt_pk_bf16_f32 v234, v116, v117
    v_cvt_pk_bf16_f32 v235, v118, v119
    s_nop 1
    v_permlane16_swap_b32 v232, v234
    v_permlane16_swap_b32 v233, v235
    buffer_store_dwordx4 v[232:235], v26, s[16:19], s67 offen offset:0
    s_waitcnt vmcnt(12)
    v_add_f32 v120, v120, v56
    v_add_f32 v121, v121, v57
    v_add_f32 v122, v122, v58
    v_add_f32 v123, v123, v59
    v_cvt_pk_bf16_f32 v28, v120, v121
    v_cvt_pk_bf16_f32 v29, v122, v123
    v_lshlrev_b32 v120, 16, v28
    v_and_b32 v121, 0xffff0000, v28
    v_lshlrev_b32 v122, 16, v29
    v_and_b32 v123, 0xffff0000, v29
    v_mul_f32 v120, v13, v120
    v_mul_f32 v121, v13, v121
    v_mul_f32 v122, v13, v122
    v_mul_f32 v123, v13, v123
    v_cvt_pk_bf16_f32 v28, v120, v121
    v_cvt_pk_bf16_f32 v29, v122, v123
    v_lshlrev_b32 v120, 16, v28
    v_and_b32 v121, 0xffff0000, v28
    v_lshlrev_b32 v122, 16, v29
    v_and_b32 v123, 0xffff0000, v29
    v_add_f32 v120, v120, v184
    v_add_f32 v121, v121, v185
    v_add_f32 v122, v122, v186
    v_add_f32 v123, v123, v187
    v_cvt_pk_bf16_f32 v236, v120, v121
    v_cvt_pk_bf16_f32 v237, v122, v123
    s_waitcnt vmcnt(11)
    v_add_f32 v124, v124, v60
    v_add_f32 v125, v125, v61
    v_add_f32 v126, v126, v62
    v_add_f32 v127, v127, v63
    v_cvt_pk_bf16_f32 v28, v124, v125
    v_cvt_pk_bf16_f32 v29, v126, v127
    v_lshlrev_b32 v124, 16, v28
    v_and_b32 v125, 0xffff0000, v28
    v_lshlrev_b32 v126, 16, v29
    v_and_b32 v127, 0xffff0000, v29
    v_mul_f32 v124, v13, v124
    v_mul_f32 v125, v13, v125
    v_mul_f32 v126, v13, v126
    v_mul_f32 v127, v13, v127
    v_cvt_pk_bf16_f32 v28, v124, v125
    v_cvt_pk_bf16_f32 v29, v126, v127
    v_lshlrev_b32 v124, 16, v28
    v_and_b32 v125, 0xffff0000, v28
    v_lshlrev_b32 v126, 16, v29
    v_and_b32 v127, 0xffff0000, v29
    v_add_f32 v124, v124, v188
    v_add_f32 v125, v125, v189
    v_add_f32 v126, v126, v190
    v_add_f32 v127, v127, v191
    v_cvt_pk_bf16_f32 v238, v124, v125
    v_cvt_pk_bf16_f32 v239, v126, v127
    s_nop 1
    v_permlane16_swap_b32 v236, v238
    v_permlane16_swap_b32 v237, v239
    buffer_store_dwordx4 v[236:239], v26, s[16:19], s67 offen offset:64
    s_add_u32 s67, s67, 32768
    s_waitcnt vmcnt(11)
    v_add_f32 v128, v128, v64
    v_add_f32 v129, v129, v65
    v_add_f32 v130, v130, v66
    v_add_f32 v131, v131, v67
    v_cvt_pk_bf16_f32 v28, v128, v129
    v_cvt_pk_bf16_f32 v29, v130, v131
    v_lshlrev_b32 v128, 16, v28
    v_and_b32 v129, 0xffff0000, v28
    v_lshlrev_b32 v130, 16, v29
    v_and_b32 v131, 0xffff0000, v29
    v_mul_f32 v128, v14, v128
    v_mul_f32 v129, v14, v129
    v_mul_f32 v130, v14, v130
    v_mul_f32 v131, v14, v131
    v_cvt_pk_bf16_f32 v28, v128, v129
    v_cvt_pk_bf16_f32 v29, v130, v131
    v_lshlrev_b32 v128, 16, v28
    v_and_b32 v129, 0xffff0000, v28
    v_lshlrev_b32 v130, 16, v29
    v_and_b32 v131, 0xffff0000, v29
    v_add_f32 v128, v128, v192
    v_add_f32 v129, v129, v193
    v_add_f32 v130, v130, v194
    v_add_f32 v131, v131, v195
    v_cvt_pk_bf16_f32 v224, v128, v129
    v_cvt_pk_bf16_f32 v225, v130, v131
    s_waitcnt vmcnt(10)
    v_add_f32 v132, v132, v68
    v_add_f32 v133, v133, v69
    v_add_f32 v134, v134, v70
    v_add_f32 v135, v135, v71
    v_cvt_pk_bf16_f32 v28, v132, v133
    v_cvt_pk_bf16_f32 v29, v134, v135
    v_lshlrev_b32 v132, 16, v28
    v_and_b32 v133, 0xffff0000, v28
    v_lshlrev_b32 v134, 16, v29
    v_and_b32 v135, 0xffff0000, v29
    v_mul_f32 v132, v14, v132
    v_mul_f32 v133, v14, v133
    v_mul_f32 v134, v14, v134
    v_mul_f32 v135, v14, v135
    v_cvt_pk_bf16_f32 v28, v132, v133
    v_cvt_pk_bf16_f32 v29, v134, v135
    v_lshlrev_b32 v132, 16, v28
    v_and_b32 v133, 0xffff0000, v28
    v_lshlrev_b32 v134, 16, v29
    v_and_b32 v135, 0xffff0000, v29
    v_add_f32 v132, v132, v196
    v_add_f32 v133, v133, v197
    v_add_f32 v134, v134, v198
    v_add_f32 v135, v135, v199
    v_cvt_pk_bf16_f32 v226, v132, v133
    v_cvt_pk_bf16_f32 v227, v134, v135
    s_nop 1
    v_permlane16_swap_b32 v224, v226
    v_permlane16_swap_b32 v225, v227
    buffer_store_dwordx4 v[224:227], v26, s[16:19], s67 offen offset:0
    s_waitcnt vmcnt(10)
    v_add_f32 v136, v136, v72
    v_add_f32 v137, v137, v73
    v_add_f32 v138, v138, v74
    v_add_f32 v139, v139, v75
    v_cvt_pk_bf16_f32 v28, v136, v137
    v_cvt_pk_bf16_f32 v29, v138, v139
    v_lshlrev_b32 v136, 16, v28
    v_and_b32 v137, 0xffff0000, v28
    v_lshlrev_b32 v138, 16, v29
    v_and_b32 v139, 0xffff0000, v29
    v_mul_f32 v136, v14, v136
    v_mul_f32 v137, v14, v137
    v_mul_f32 v138, v14, v138
    v_mul_f32 v139, v14, v139
    v_cvt_pk_bf16_f32 v28, v136, v137
    v_cvt_pk_bf16_f32 v29, v138, v139
    v_lshlrev_b32 v136, 16, v28
    v_and_b32 v137, 0xffff0000, v28
    v_lshlrev_b32 v138, 16, v29
    v_and_b32 v139, 0xffff0000, v29
    v_add_f32 v136, v136, v200
    v_add_f32 v137, v137, v201
    v_add_f32 v138, v138, v202
    v_add_f32 v139, v139, v203
    v_cvt_pk_bf16_f32 v228, v136, v137
    v_cvt_pk_bf16_f32 v229, v138, v139
    s_waitcnt vmcnt(9)
    v_add_f32 v140, v140, v76
    v_add_f32 v141, v141, v77
    v_add_f32 v142, v142, v78
    v_add_f32 v143, v143, v79
    v_cvt_pk_bf16_f32 v28, v140, v141
    v_cvt_pk_bf16_f32 v29, v142, v143
    v_lshlrev_b32 v140, 16, v28
    v_and_b32 v141, 0xffff0000, v28
    v_lshlrev_b32 v142, 16, v29
    v_and_b32 v143, 0xffff0000, v29
    v_mul_f32 v140, v14, v140
    v_mul_f32 v141, v14, v141
    v_mul_f32 v142, v14, v142
    v_mul_f32 v143, v14, v143
    v_cvt_pk_bf16_f32 v28, v140, v141
    v_cvt_pk_bf16_f32 v29, v142, v143
    v_lshlrev_b32 v140, 16, v28
    v_and_b32 v141, 0xffff0000, v28
    v_lshlrev_b32 v142, 16, v29
    v_and_b32 v143, 0xffff0000, v29
    v_add_f32 v140, v140, v204
    v_add_f32 v141, v141, v205
    v_add_f32 v142, v142, v206
    v_add_f32 v143, v143, v207
    v_cvt_pk_bf16_f32 v230, v140, v141
    v_cvt_pk_bf16_f32 v231, v142, v143
    s_nop 1
    v_permlane16_swap_b32 v228, v230
    v_permlane16_swap_b32 v229, v231
    buffer_store_dwordx4 v[228:231], v26, s[16:19], s67 offen offset:64
    s_add_u32 s67, s67, 32768
    s_waitcnt vmcnt(9)
    v_add_f32 v144, v144, v80
    v_add_f32 v145, v145, v81
    v_add_f32 v146, v146, v82
    v_add_f32 v147, v147, v83
    v_cvt_pk_bf16_f32 v28, v144, v145
    v_cvt_pk_bf16_f32 v29, v146, v147
    v_lshlrev_b32 v144, 16, v28
    v_and_b32 v145, 0xffff0000, v28
    v_lshlrev_b32 v146, 16, v29
    v_and_b32 v147, 0xffff0000, v29
    v_mul_f32 v144, v15, v144
    v_mul_f32 v145, v15, v145
    v_mul_f32 v146, v15, v146
    v_mul_f32 v147, v15, v147
    v_cvt_pk_bf16_f32 v28, v144, v145
    v_cvt_pk_bf16_f32 v29, v146, v147
    v_lshlrev_b32 v144, 16, v28
    v_and_b32 v145, 0xffff0000, v28
    v_lshlrev_b32 v146, 16, v29
    v_and_b32 v147, 0xffff0000, v29
    v_add_f32 v144, v144, v208
    v_add_f32 v145, v145, v209
    v_add_f32 v146, v146, v210
    v_add_f32 v147, v147, v211
    v_cvt_pk_bf16_f32 v232, v144, v145
    v_cvt_pk_bf16_f32 v233, v146, v147
    s_waitcnt vmcnt(8)
    v_add_f32 v148, v148, v84
    v_add_f32 v149, v149, v85
    v_add_f32 v150, v150, v86
    v_add_f32 v151, v151, v87
    v_cvt_pk_bf16_f32 v28, v148, v149
    v_cvt_pk_bf16_f32 v29, v150, v151
    v_lshlrev_b32 v148, 16, v28
    v_and_b32 v149, 0xffff0000, v28
    v_lshlrev_b32 v150, 16, v29
    v_and_b32 v151, 0xffff0000, v29
    v_mul_f32 v148, v15, v148
    v_mul_f32 v149, v15, v149
    v_mul_f32 v150, v15, v150
    v_mul_f32 v151, v15, v151
    v_cvt_pk_bf16_f32 v28, v148, v149
    v_cvt_pk_bf16_f32 v29, v150, v151
    v_lshlrev_b32 v148, 16, v28
    v_and_b32 v149, 0xffff0000, v28
    v_lshlrev_b32 v150, 16, v29
    v_and_b32 v151, 0xffff0000, v29
    v_add_f32 v148, v148, v212
    v_add_f32 v149, v149, v213
    v_add_f32 v150, v150, v214
    v_add_f32 v151, v151, v215
    v_cvt_pk_bf16_f32 v234, v148, v149
    v_cvt_pk_bf16_f32 v235, v150, v151
    s_nop 1
    v_permlane16_swap_b32 v232, v234
    v_permlane16_swap_b32 v233, v235
    buffer_store_dwordx4 v[232:235], v26, s[16:19], s67 offen offset:0
    s_waitcnt vmcnt(8)
    v_add_f32 v152, v152, v88
    v_add_f32 v153, v153, v89
    v_add_f32 v154, v154, v90
    v_add_f32 v155, v155, v91
    v_cvt_pk_bf16_f32 v28, v152, v153
    v_cvt_pk_bf16_f32 v29, v154, v155
    v_lshlrev_b32 v152, 16, v28
    v_and_b32 v153, 0xffff0000, v28
    v_lshlrev_b32 v154, 16, v29
    v_and_b32 v155, 0xffff0000, v29
    v_mul_f32 v152, v15, v152
    v_mul_f32 v153, v15, v153
    v_mul_f32 v154, v15, v154
    v_mul_f32 v155, v15, v155
    v_cvt_pk_bf16_f32 v28, v152, v153
    v_cvt_pk_bf16_f32 v29, v154, v155
    v_lshlrev_b32 v152, 16, v28
    v_and_b32 v153, 0xffff0000, v28
    v_lshlrev_b32 v154, 16, v29
    v_and_b32 v155, 0xffff0000, v29
    v_add_f32 v152, v152, v216
    v_add_f32 v153, v153, v217
    v_add_f32 v154, v154, v218
    v_add_f32 v155, v155, v219
    v_cvt_pk_bf16_f32 v236, v152, v153
    v_cvt_pk_bf16_f32 v237, v154, v155
    s_waitcnt vmcnt(7)
    v_add_f32 v156, v156, v92
    v_add_f32 v157, v157, v93
    v_add_f32 v158, v158, v94
    v_add_f32 v159, v159, v95
    v_cvt_pk_bf16_f32 v28, v156, v157
    v_cvt_pk_bf16_f32 v29, v158, v159
    v_lshlrev_b32 v156, 16, v28
    v_and_b32 v157, 0xffff0000, v28
    v_lshlrev_b32 v158, 16, v29
    v_and_b32 v159, 0xffff0000, v29
    v_mul_f32 v156, v15, v156
    v_mul_f32 v157, v15, v157
    v_mul_f32 v158, v15, v158
    v_mul_f32 v159, v15, v159
    v_cvt_pk_bf16_f32 v28, v156, v157
    v_cvt_pk_bf16_f32 v29, v158, v159
    v_lshlrev_b32 v156, 16, v28
    v_and_b32 v157, 0xffff0000, v28
    v_lshlrev_b32 v158, 16, v29
    v_and_b32 v159, 0xffff0000, v29
    v_add_f32 v156, v156, v220
    v_add_f32 v157, v157, v221
    v_add_f32 v158, v158, v222
    v_add_f32 v159, v159, v223
    v_cvt_pk_bf16_f32 v238, v156, v157
    v_cvt_pk_bf16_f32 v239, v158, v159
    s_nop 1
    v_permlane16_swap_b32 v236, v238
    v_permlane16_swap_b32 v237, v239
    buffer_store_dwordx4 v[236:239], v26, s[16:19], s67 offen offset:64
    s_waitcnt vmcnt(0)
k2_kernel_done:
    s_endpgm
.section .rodata,"a"
.p2align 6
.amdhsa_kernel k1_kernel
  .amdhsa_next_free_vgpr 256
  .amdhsa_next_free_sgpr 102
  .amdhsa_accum_offset 256
  .amdhsa_group_segment_fixed_size 0
  .amdhsa_kernarg_size 88
  .amdhsa_user_sgpr_count 2
  .amdhsa_user_sgpr_kernarg_segment_ptr 1
  .amdhsa_system_sgpr_workgroup_id_x 1
.end_amdhsa_kernel
.p2align 6
.amdhsa_kernel k2_kernel
  .amdhsa_next_free_vgpr 256
  .amdhsa_next_free_sgpr 102
  .amdhsa_accum_offset 256
  .amdhsa_group_segment_fixed_size 0
  .amdhsa_kernarg_size 88
  .amdhsa_user_sgpr_count 2
  .amdhsa_user_sgpr_kernarg_segment_ptr 1
  .amdhsa_system_sgpr_workgroup_id_x 1
.end_amdhsa_kernel
```
